```python
import torch

def _softmax(x, axis=-1):
    return torch.softmax(x, dim=axis)
def _gelu(x):
    return torch.nn.functional.gelu(x, approximate="tanh")
def _silu(x):
    return torch.nn.functional.silu(x)
def _sigmoid(x):
    return torch.sigmoid(x)
def _layernorm(x, axis=-1, eps=1e-5):
    m = x.mean(dim=axis, keepdim=True)
    v = x.var(dim=axis, keepdim=True, unbiased=False)
    return (x - m) / torch.sqrt(v + eps)
def _scatter_add(tgt, idx, src, axis=0):
    return tgt.clone().index_add_(axis, idx, src)
def _segment_sum(src, seg, n):
    out = torch.zeros((n,) + src.shape[1:], dtype=src.dtype)
    return out.index_add_(0, seg, src)
def _pad(x, pw):
    flat = tuple(v for pair in reversed(pw) for v in pair)
    return torch.nn.functional.pad(x, flat)

kernel_name = 'standalone__ssm_conv_s4__prompt'

def setup_inputs():

    _w = (lambda a: (lambda t: t.to(torch.bfloat16) if t.is_floating_point() else t)(torch.as_tensor(a)))
    B, L, D, N = 1, 2048, 512, 128
    A_re = -(lambda _x: torch.exp(torch.as_tensor(_x)))((lambda *s: torch.randn(*s, dtype=torch.bfloat16) * 6.4)(D, N))
    A_im = torch.pi * (lambda *s: torch.randn(*s, dtype=torch.bfloat16) * 0.05)(D, N)
    B_re = (lambda *s: torch.randn(*s, dtype=torch.bfloat16) * 0.1)(D, N)
    B_im = (lambda *s: torch.randn(*s, dtype=torch.bfloat16) * 0.1)(D, N)
    C_re = (lambda *s: torch.randn(*s, dtype=torch.bfloat16) * 0.1)(D, N)
    C_im = (lambda *s: torch.randn(*s, dtype=torch.bfloat16) * 0.1)(D, N)
    log_dt = (lambda *s: torch.randn(*s, dtype=torch.bfloat16) * 0.05)(D) * 0.5 - 4.0
    Dskip = (lambda *s: torch.randn(*s, dtype=torch.bfloat16) * 0.05)(D)
    return {
        "u": _w((lambda *s: torch.randn(*s, dtype=torch.bfloat16) * 0.05)(B, L, D)),
        "A_re": _w(A_re),
        "A_im": _w(A_im),
        "B_re": _w(B_re),
        "B_im": _w(B_im),
        "C_re": _w(C_re),
        "C_im": _w(C_im),
        "log_dt": _w(log_dt),
        "Dskip": _w(Dskip),
    }

def reference(u, A_re, A_im, B_re, B_im, C_re, C_im, log_dt, Dskip):
    Bsz, L, D = u.shape
    dt = torch.exp(log_dt)[:, None]
    A = A_re + 1j * A_im
    Bc = B_re + 1j * B_im
    Cc = C_re + 1j * C_im
    logdA = dt * A
    dB = dt * Bc
    l = (lambda x, dt: x.to(dt))(torch.arange(L), A_re.dtype)
    P = torch.exp(logdA[:, :, None] * l[None, None, :])
    K = torch.einsum("dn,dnl,dn->dl", Cc, P, dB).real
    L2 = 2 * L
    Kp = _pad(K, ((0, 0), (0, L)))
    up = (lambda x, *d: x.permute(*d))(u, 0, 2, 1)
    up = _pad(up, ((0, 0), (0, 0), (0, L)))
    Kf = (lambda x, axes=(-2,-1): torch.fft.rfft2(x.float(), dim=axes))(Kp[:, None, :], axes=(-2, -1))
    Uf = (lambda x, axes=(-2,-1): torch.fft.rfft2(x.float(), dim=axes))(up[:, :, None, :], axes=(-2, -1))
    Yf = Uf * Kf[None, :, :, :]
    y = (lambda x, s, axes=(-2,-1): torch.fft.irfft2(x, s=s, dim=axes).to(torch.bfloat16))(Yf, (1, L2), axes=(-2, -1))[:, :, 0, :L]
    y = (lambda x, *d: x.permute(*d))(y, 0, 2, 1) + u * Dskip[None, None, :]
    return y
```

```asm
; @launch grid=(256,1,1) block=(768,1,1) lds=144704
.amdgcn_target "amdgcn-amd-amdhsa--gfx950"
.text
.globl standalone__ssm_conv_s4__prompt_kernel
.p2align 8
.type standalone__ssm_conv_s4__prompt_kernel,@function
standalone__ssm_conv_s4__prompt_kernel:
    s_cmp_ge_u32 s2, 256
    s_cbranch_scc1 L_end
    s_load_dwordx16 s[16:31], s[0:1], 0
    s_load_dwordx4 s[32:35], s[0:1], 64
    s_getpc_b64 s[14:15]
L_pc:
    v_lshlrev_b32 v2, 5, v0
    v_min_u32 v2, L_end-L_pc, v2
    global_load_dword v139, v2, s[14:15]
    v_lshrrev_b32 v4, 6, v0
    v_and_b32 v1, 63, v0
    v_readfirstlane_b32 s4, v4
    s_and_b32 s5, s2, 7
    s_lshr_b32 s6, s2, 3
    s_and_b32 s7, s6, 1
    s_lshr_b32 s9, s6, 1
    s_lshl_b32 s9, s9, 2
    s_lshl_b32 s8, s5, 6
    s_add_u32 s8, s8, s9
    s_cmp_ge_u32 s4, 8
    s_cbranch_scc1 L_uwave
    s_and_b32 s9, s4, 3
    s_lshr_b32 s10, s4, 2
    s_add_u32 s11, s8, s9
    s_lshl_b32 s11, s11, 8
    s_lshl_b32 s12, s10, 7
    s_add_u32 s11, s11, s12
    v_lshlrev_b32 v2, 1, v1
    v_add_u32 v2, s11, v2
    s_lshl_b32 s11, s8, 1
    v_mov_b32 v4, 0
    v_mov_b32 v5, 0
    v_mov_b32 v6, 0
    v_mov_b32 v7, 0
    v_mov_b32 v8, 0
    v_mov_b32 v9, 0
    s_waitcnt lgkmcnt(0)
    global_load_short_d16_hi v5, v2, s[20:21]
    global_load_short_d16_hi v4, v2, s[18:19]
    global_load_short_d16_hi v6, v2, s[22:23]
    global_load_short_d16_hi v7, v2, s[24:25]
    global_load_short_d16_hi v8, v2, s[26:27]
    global_load_short_d16_hi v9, v2, s[28:29]
    s_load_dwordx2 s[42:43], s[30:31], s11
    s_load_dwordx2 s[46:47], s[32:33], s11
    s_mul_i32 s12, s4, 4608
    s_mov_b32 m0, s12
    s_mul_i32 s40, s9, 4608
    s_add_u32 s40, s40, 36864
    v_and_b32 v16, 15, v1
    v_lshrrev_b32 v17, 4, v1
    v_mul_u32_u24 v18, 288, v16
    v_lshlrev_b32 v19, 4, v17
    v_add3_u32 v13, v18, v19, s12
    s_mul_i32 s11, s9, 3072
    s_add_u32 s11, s11, 130048
    v_lshlrev_b32 v166, 4, v1
    v_add_u32 v166, s11, v166
    s_lshl_b32 s11, s9, 2
    s_add_u32 s11, s11, 142336
    v_mov_b32 v15, s11
    s_cmp_lg_u32 s10, 0
    s_cbranch_scc1 L_prolB
    v_lshlrev_b32 v20, 3, v1
    v_add_u32 v20, s40, v20
    v_mov_b32 v22, 0
    v_mov_b32 v23, 0
    ds_write_b64 v20, v[22:23]
    ds_write_b32 v15, v22
    ds_write_b32 v15, v22 offset:16
    v_lshlrev_b32 v20, 4, v16
    v_add_u32 v20, s40, v20
    v_lshlrev_b32 v21, 4, v1
    v_add_u32 v21, 142400, v21
    v_lshl_add_u32 v22, v17, 10, v20
    v_add_u32 v22, 2520, v22
    v_cmp_gt_u32 vcc, 33, v1
    v_lshl_add_u32 v23, v17, 9, v20
    v_lshl_add_u32 v24, v17, 8, v20
    v_cndmask_b32 v156, v21, v22, vcc
    v_cmp_gt_u32 vcc, 32, v1
    v_add_u32 v25, 476, v23
    v_add_u32 v26, 992, v24
    v_cndmask_b32 v157, v21, v22, vcc
    v_cndmask_b32 v159, v25, v21, vcc
    v_cndmask_b32 v160, v21, v26, vcc
    v_add_u32 v25, 990, v24
    v_add_u32 v26, 478, v23
    v_cndmask_b32 v161, v26, v25, vcc
    v_and_b32 v25, 33, v1
    v_cmp_eq_u32 vcc, 0, v25
    v_lshrrev_b32 v26, 1, v17
    v_and_b32 v27, 1, v17
    v_cndmask_b32 v158, v21, v22, vcc
    v_lshl_add_u32 v162, v26, 8, v20
    v_lshl_add_u32 v162, v27, 3, v162
    v_add_u32 v162, 480, v162
    v_and_b32 v25, 3, v16
    v_sub_u32 v25, 3, v25
    v_mul_u32_u24 v25, 4160, v25
    v_lshrrev_b32 v26, 2, v16
    v_lshlrev_b32 v26, 3, v26
    v_sub_u32 v163, v25, v26
    s_mul_i32 s11, s9, 16640
    s_add_u32 s11, s11, 55320
    v_add3_u32 v163, v163, v19, s11
    v_lshlrev_b32 v164, 5, v16
    v_add3_u32 v164, v164, v19, s40
    v_lshlrev_b32 v165, 5, v16
    v_lshlrev_b32 v25, 3, v17
    s_lshl_b32 s11, s9, 11
    s_add_u32 s11, s11, 121856
    v_add3_u32 v165, v165, v25, s11
    v_mov_b32 v140, 0
    v_mov_b32 v141, 0
    v_mov_b32 v142, 0
    v_mov_b32 v143, 0
    v_mov_b32 v144, 0
    v_mov_b32 v145, 0
    v_mov_b32 v146, 0
    v_mov_b32 v147, 0
    v_mov_b32 v148, 0
    v_mov_b32 v149, 0
    v_mov_b32 v150, 0
    v_mov_b32 v151, 0
    v_mov_b32 v152, 0
    v_mov_b32 v153, 0
    v_mov_b32 v154, 0
    v_mov_b32 v155, 0
L_prolB:
    s_waitcnt lgkmcnt(0)
    s_barrier
    s_lshl_b32 s11, s9, 4
    s_lshr_b64 s[42:43], s[42:43], s11
    s_lshl_b32 s42, s42, 16
    s_lshr_b64 s[46:47], s[46:47], s11
    s_lshl_b32 s46, s46, 16
    s_mov_b32 s41, 0x3fb8aa3b
    v_mov_b32 v16, s42
    v_mul_f32 v17, 0x3fb8aa3b, v16
    v_mov_b32 v167, 0
    v_rndne_f32 v17, v17
    v_writelane_b32 v167, s46, 0
    v_fma_f32 v18, v16, s41, -v17
    v_fmac_f32 v18, 0x32a57060, v16
    v_exp_f32 v18, v18
    v_cvt_i32_f32 v17, v17
    v_ldexp_f32 v18, v18, v17
    v_cvt_pk_bf16_f32 v18, v18, v18
    v_and_b32 v10, 0xffff0000, v18
    s_mov_b32 s41, 0x3e22f983
    v_mul_f32 v11, 0x3fb8aa3b, v10
    v_mul_f32 v12, 0x3e22f983, v10
    v_fma_f32 v3, v10, s41, -v12
    v_fmac_f32 v3, 0x31dc9c88, v10
    s_waitcnt vmcnt(0)
    s_cmp_lg_u32 s10, 0
    s_cbranch_scc1 L_kgenB
    s_setprio 0
    v_mul_f32 v16, v12, v5
    v_mul_f32 v17, v11, v4
    v_fma_f32 v18, v5, v12, -v16
    v_pk_mul_f32 v[20:21], v[6:7], v[10:11] op_sel_hi:[1,0]
    v_fmac_f32 v18, v3, v5
    v_mul_f32 v19, 0x41000000, v16
    v_mul_f32 v22, 0x41000000, v17
    v_rndne_f32 v23, v19
    v_exp_f32 v24, v22
    v_sub_f32 v25, v19, v23
    v_mul_f32 v26, 0x43000000, v16
    v_fmac_f32 v25, 0x41000000, v18
    v_mul_f32 v27, 0x43000000, v17
    v_cos_f32 v28, v25
    v_sin_f32 v29, v25
    v_rndne_f32 v30, v26
    v_mul_f32 v32, v24, v28
    v_mul_f32_e64 v33, -v24, v29
    v_exp_f32 v31, v27
    v_sub_f32 v34, v26, v30
    v_mov_b32 v35, 0x3f80
    v_fmac_f32 v34, 0x43000000, v18
    v_pk_mul_f32 v[36:37], v[32:33], v[32:33] op_sel_hi:[0,1]
    v_cos_f32 v38, v34
    ds_write_addtid_b32 v35 offset:0
    v_sin_f32 v39, v34
    v_mul_f32 v40, v31, v38
    v_pk_fma_f32 v[42:43], v[32:33], v[32:33], v[36:37] op_sel:[1,1,0] op_sel_hi:[1,0,1] neg_lo:[0,1,0]
    v_mul_f32 v41, v31, v39
    v_cvt_pk_bf16_f32 v44, v32, v33
    v_cvt_pk_bf16_f32 v45, v42, v43
    v_pk_mul_f32 v[46:47], v[8:9], v[20:21] op_sel_hi:[0,1]
    v_pk_mul_f32 v[48:49], v[32:33], v[42:43] op_sel_hi:[0,1]
    ds_write_addtid_b32 v44 offset:288
    ds_write_addtid_b32 v45 offset:576
    v_pk_fma_f32 v[50:51], v[8:9], v[20:21], v[46:47] op_sel:[1,1,0] op_sel_hi:[1,0,1] neg_lo:[0,1,0]
    v_pk_fma_f32 v[52:53], v[32:33], v[42:43], v[48:49] op_sel:[1,1,0] op_sel_hi:[1,0,1] neg_lo:[0,1,0]
    v_pk_mul_f32 v[54:55], v[42:43], v[42:43] op_sel_hi:[0,1]
    v_cvt_pk_bf16_f32 v56, v52, v53
    v_pk_fma_f32 v[58:59], v[42:43], v[42:43], v[54:55] op_sel:[1,1,0] op_sel_hi:[1,0,1] neg_lo:[0,1,0]
    v_pk_mul_f32 v[60:61], v[52:53], v[42:43] op_sel_hi:[0,1]
    v_cvt_pk_bf16_f32 v57, v58, v59
    ds_write_addtid_b32 v56 offset:864
    v_pk_fma_f32 v[62:63], v[52:53], v[42:43], v[60:61] op_sel:[1,1,0] op_sel_hi:[1,0,1] neg_lo:[0,1,0]
    v_pk_mul_f32 v[64:65], v[58:59], v[42:43] op_sel_hi:[0,1]
    ds_write_addtid_b32 v57 offset:1152
    v_cvt_pk_bf16_f32 v66, v62, v63
    v_pk_fma_f32 v[68:69], v[58:59], v[42:43], v[64:65] op_sel:[1,1,0] op_sel_hi:[1,0,1] neg_lo:[0,1,0]
    v_pk_mul_f32 v[70:71], v[40:41], v[40:41] op_sel_hi:[0,1]
    v_cvt_pk_bf16_f32 v67, v68, v69
    ds_write_addtid_b32 v66 offset:1440
    v_pk_fma_f32 v[72:73], v[40:41], v[40:41], v[70:71] op_sel:[1,1,0] op_sel_hi:[1,0,1] neg_lo:[0,1,0]
    v_pk_mul_f32 v[74:75], v[62:63], v[42:43] op_sel_hi:[0,1]
    ds_write_addtid_b32 v67 offset:1728
    v_pk_fma_f32 v[76:77], v[62:63], v[42:43], v[74:75] op_sel:[1,1,0] op_sel_hi:[1,0,1] neg_lo:[0,1,0]
    v_pk_mul_f32 v[78:79], v[68:69], v[42:43] op_sel_hi:[0,1]
    v_cvt_pk_bf16_f32 v80, v76, v77
    v_pk_fma_f32 v[82:83], v[68:69], v[42:43], v[78:79] op_sel:[1,1,0] op_sel_hi:[1,0,1] neg_lo:[0,1,0]
    v_pk_mul_f32 v[84:85], v[76:77], v[42:43] op_sel_hi:[0,1]
    v_cvt_pk_bf16_f32 v81, v82, v83
    ds_write_addtid_b32 v80 offset:2016
    v_pk_fma_f32 v[86:87], v[76:77], v[42:43], v[84:85] op_sel:[1,1,0] op_sel_hi:[1,0,1] neg_lo:[0,1,0]
    v_pk_mul_f32 v[88:89], v[72:73], v[72:73] op_sel_hi:[0,1]
    ds_write_addtid_b32 v81 offset:2304
    v_cvt_pk_bf16_f32 v90, v86, v87
    v_pk_fma_f32 v[92:93], v[72:73], v[72:73], v[88:89] op_sel:[1,1,0] op_sel_hi:[1,0,1] neg_lo:[0,1,0]
    v_pk_mul_f32 v[94:95], v[82:83], v[42:43] op_sel_hi:[0,1]
    v_pk_mul_f32 v[96:97], v[86:87], v[42:43] op_sel_hi:[0,1]
    ds_write_addtid_b32 v90 offset:2592
    v_pk_fma_f32 v[98:99], v[82:83], v[42:43], v[94:95] op_sel:[1,1,0] op_sel_hi:[1,0,1] neg_lo:[0,1,0]
    v_pk_fma_f32 v[100:101], v[86:87], v[42:43], v[96:97] op_sel:[1,1,0] op_sel_hi:[1,0,1] neg_lo:[0,1,0]
    v_cvt_pk_bf16_f32 v91, v98, v99
    v_cvt_pk_bf16_f32 v102, v100, v101
    v_pk_mul_f32 v[104:105], v[98:99], v[42:43] op_sel_hi:[0,1]
    v_pk_mul_f32 v[106:107], v[92:93], v[92:93] op_sel_hi:[0,1]
    ds_write_addtid_b32 v91 offset:2880
    ds_write_addtid_b32 v102 offset:3168
    v_pk_fma_f32 v[108:109], v[98:99], v[42:43], v[104:105] op_sel:[1,1,0] op_sel_hi:[1,0,1] neg_lo:[0,1,0]
    v_pk_fma_f32 v[110:111], v[92:93], v[92:93], v[106:107] op_sel:[1,1,0] op_sel_hi:[1,0,1] neg_lo:[0,1,0]
    v_cvt_pk_bf16_f32 v103, v108, v109
    v_pk_mul_f32 v[112:113], v[100:101], v[42:43] op_sel_hi:[0,1]
    v_pk_mul_f32 v[114:115], v[108:109], v[42:43] op_sel_hi:[0,1]
    v_pk_fma_f32 v[116:117], v[100:101], v[42:43], v[112:113] op_sel:[1,1,0] op_sel_hi:[1,0,1] neg_lo:[0,1,0]
    ds_write_addtid_b32 v103 offset:3456
    v_cvt_pk_bf16_f32 v118, v116, v117
    v_pk_fma_f32 v[120:121], v[108:109], v[42:43], v[114:115] op_sel:[1,1,0] op_sel_hi:[1,0,1] neg_lo:[0,1,0]
    v_pk_mul_f32 v[122:123], v[116:117], v[42:43] op_sel_hi:[0,1]
    v_cvt_pk_bf16_f32 v119, v120, v121
    ds_write_addtid_b32 v118 offset:3744
    v_pk_fma_f32 v[136:137], v[116:117], v[42:43], v[122:123] op_sel:[1,1,0] op_sel_hi:[1,0,1] neg_lo:[0,1,0]
    v_rndne_f32 v138, v16
    ds_write_addtid_b32 v119 offset:4032
    v_cvt_pk_bf16_f32 v139, v136, v137
    v_exp_f32 v22, v17
    v_sub_f32 v19, v16, v138
    v_pk_mul_f32 v[24:25], v[50:51], v[110:111] op_sel_hi:[0,1]
    ds_write_addtid_b32 v139 offset:4320
    ds_read_b128 v[26:29], v13 offset:0
    ds_read_b128 v[34:37], v13 offset:64
    ds_read_b128 v[44:47], v13 offset:128
    ds_read_b128 v[30:33], v13 offset:192
    v_add_f32 v23, v19, v18
    v_pk_fma_f32 v[38:39], v[50:51], v[110:111], v[24:25] op_sel:[1,1,0] op_sel_hi:[1,0,1] neg_lo:[0,1,0]
    v_cos_f32 v20, v23
    v_sin_f32 v21, v23
    v_pk_mul_f32 v[48:49], v[38:39], v[40:41] op_sel_hi:[0,1]
    v_mul_f32 v54, v22, v20
    v_mul_f32 v55, v22, v21
    v_pk_fma_f32 v[52:53], v[38:39], v[40:41], v[48:49] op_sel:[1,1,0] op_sel_hi:[1,0,1] neg_lo:[0,1,0]
    v_cvt_pk_bf16_f32 v56, v38, v39
    v_pk_mul_f32 v[60:61], v[38:39], v[72:73] op_sel_hi:[0,1]
    v_cvt_pk_bf16_f32 v57, v52, v53
    v_pk_fma_f32 v[58:59], v[38:39], v[72:73], v[60:61] op_sel:[1,1,0] op_sel_hi:[1,0,1] neg_lo:[0,1,0]
    ds_write_addtid_b32 v56 offset:0
    v_pk_mul_f32 v[64:65], v[52:53], v[72:73] op_sel_hi:[0,1]
    ds_write_addtid_b32 v57 offset:288
    v_pk_fma_f32 v[70:71], v[52:53], v[72:73], v[64:65] op_sel:[1,1,0] op_sel_hi:[1,0,1] neg_lo:[0,1,0]
    v_cvt_pk_bf16_f32 v66, v58, v59
    v_pk_mul_f32 v[62:63], v[58:59], v[72:73] op_sel_hi:[0,1]
    v_cvt_pk_bf16_f32 v67, v70, v71
    v_pk_fma_f32 v[74:75], v[58:59], v[72:73], v[62:63] op_sel:[1,1,0] op_sel_hi:[1,0,1] neg_lo:[0,1,0]
    ds_write_addtid_b32 v66 offset:576
    v_pk_mul_f32 v[68:69], v[70:71], v[72:73] op_sel_hi:[0,1]
    ds_write_addtid_b32 v67 offset:864
    v_pk_fma_f32 v[78:79], v[70:71], v[72:73], v[68:69] op_sel:[1,1,0] op_sel_hi:[1,0,1] neg_lo:[0,1,0]
    v_cvt_pk_bf16_f32 v80, v74, v75
    v_pk_mul_f32 v[76:77], v[74:75], v[72:73] op_sel_hi:[0,1]
    v_cvt_pk_bf16_f32 v84, v78, v79
    v_pk_fma_f32 v[88:89], v[74:75], v[72:73], v[76:77] op_sel:[1,1,0] op_sel_hi:[1,0,1] neg_lo:[0,1,0]
    ds_write_addtid_b32 v80 offset:1152
    v_pk_mul_f32 v[82:83], v[78:79], v[72:73] op_sel_hi:[0,1]
    ds_write_addtid_b32 v84 offset:1440
    v_pk_fma_f32 v[94:95], v[78:79], v[72:73], v[82:83] op_sel:[1,1,0] op_sel_hi:[1,0,1] neg_lo:[0,1,0]
    v_cvt_pk_bf16_f32 v85, v88, v89
    v_pk_mul_f32 v[86:87], v[88:89], v[72:73] op_sel_hi:[0,1]
    v_cvt_pk_bf16_f32 v81, v94, v95
    v_pk_fma_f32 v[96:97], v[88:89], v[72:73], v[86:87] op_sel:[1,1,0] op_sel_hi:[1,0,1] neg_lo:[0,1,0]
    ds_write_addtid_b32 v85 offset:1728
    v_cvt_pk_bf16_f32 v90, v96, v97
    ds_write_addtid_b32 v81 offset:2016
    v_pk_mul_f32 v[98:99], v[54:55], v[54:55] op_sel_hi:[0,1]
    v_pk_mul_f32 v[104:105], v[50:51], v[72:73] op_sel_hi:[0,1]
    ds_write_addtid_b32 v90 offset:2304
    ds_read_b128 v[100:103], v13 offset:0
    ds_read_b128 v[106:109], v13 offset:64
    ds_read_b128 v[112:115], v13 offset:128
    ds_read_b128 v[120:123], v13 offset:192
    v_pk_fma_f32 v[42:43], v[54:55], v[54:55], v[98:99] op_sel:[1,1,0] op_sel_hi:[1,0,1] neg_lo:[0,1,0]
    v_pk_fma_f32 v[116:117], v[50:51], v[72:73], v[104:105] op_sel:[1,1,0] op_sel_hi:[1,0,1] neg_lo:[0,1,0]
    v_pk_mul_f32 v[118:119], v[42:43], v[42:43] op_sel_hi:[0,1]
    v_pk_mul_f32 v[136:137], v[50:51], v[92:93] op_sel_hi:[0,1]
    v_pk_fma_f32 v[16:17], v[42:43], v[42:43], v[118:119] op_sel:[1,1,0] op_sel_hi:[1,0,1] neg_lo:[0,1,0]
    v_pk_fma_f32 v[138:139], v[50:51], v[92:93], v[136:137] op_sel:[1,1,0] op_sel_hi:[1,0,1] neg_lo:[0,1,0]
    v_pk_mul_f32 v[18:19], v[116:117], v[42:43] op_sel_hi:[0,1]
    v_pk_mul_f32 v[24:25], v[138:139], v[16:17] op_sel_hi:[0,1]
    v_pk_fma_f32 v[110:111], v[116:117], v[42:43], v[18:19] op_sel:[1,1,0] op_sel_hi:[1,0,1] neg_lo:[0,1,0]
    v_pk_fma_f32 v[20:21], v[138:139], v[16:17], v[24:25] op_sel:[1,1,0] op_sel_hi:[1,0,1] neg_lo:[0,1,0]
    v_pk_mul_f32 v[22:23], v[110:111], v[42:43] op_sel_hi:[0,1]
    v_pk_mul_f32 v[48:49], v[116:117], v[40:41] op_sel_hi:[0,1]
    v_pk_fma_f32 v[38:39], v[110:111], v[42:43], v[22:23] op_sel:[1,1,0] op_sel_hi:[1,0,1] neg_lo:[0,1,0]
    v_pk_fma_f32 v[60:61], v[116:117], v[40:41], v[48:49] op_sel:[1,1,0] op_sel_hi:[1,0,1] neg_lo:[0,1,0]
    v_pk_mul_f32 v[56:57], v[38:39], v[42:43] op_sel_hi:[0,1]
    v_pk_mul_f32 v[52:53], v[110:111], v[40:41] op_sel_hi:[0,1]
    v_pk_fma_f32 v[64:65], v[38:39], v[42:43], v[56:57] op_sel:[1,1,0] op_sel_hi:[1,0,1] neg_lo:[0,1,0]
    v_pk_fma_f32 v[58:59], v[110:111], v[40:41], v[52:53] op_sel:[1,1,0] op_sel_hi:[1,0,1] neg_lo:[0,1,0]
    v_pk_mul_f32 v[62:63], v[38:39], v[40:41] op_sel_hi:[0,1]
    v_pk_mul_f32 v[66:67], v[64:65], v[40:41] op_sel_hi:[0,1]
    v_pk_fma_f32 v[68:69], v[38:39], v[40:41], v[62:63] op_sel:[1,1,0] op_sel_hi:[1,0,1] neg_lo:[0,1,0]
    s_setprio 1
    v_pk_fma_f32 v[70:71], v[64:65], v[40:41], v[66:67] op_sel:[1,1,0] op_sel_hi:[1,0,1] neg_lo:[0,1,0]
    v_pk_mul_f32 v[74:75], v[138:139], v[40:41] op_sel_hi:[0,1]
    s_waitcnt lgkmcnt(0)
    v_mfma_f32_16x16x32_bf16 v[132:135], v[100:103], v[26:29], 0
    v_cvt_pk_bf16_f32 v91, v116, v117
    v_mfma_f32_16x16x32_bf16 v[132:135], v[106:109], v[34:37], v[132:135]
    v_cvt_pk_bf16_f32 v76, v60, v61
    v_mfma_f32_16x16x32_bf16 v[132:135], v[112:115], v[44:47], v[132:135]
    ds_write_addtid_b32 v91 offset:0
    v_mfma_f32_16x16x32_bf16 v[132:135], v[120:123], v[30:33], v[132:135]
    ds_write_addtid_b32 v76 offset:1152
    v_cvt_pk_bf16_f32 v77, v110, v111
    v_cvt_pk_bf16_f32 v80, v58, v59
    v_cvt_pk_bf16_f32 v84, v38, v39
    v_cvt_pk_bf16_f32 v78, v68, v69
    ds_write_addtid_b32 v77 offset:288
    ds_write_addtid_b32 v80 offset:1440
    ds_write_addtid_b32 v84 offset:576
    ds_write_addtid_b32 v78 offset:1728
    v_cvt_pk_bf16_f32 v79, v64, v65
    v_cvt_pk_bf16_f32 v82, v70, v71
    v_cvt_pk_bf16_f32 v83, v138, v139
    v_cvt_pk_bf16_f32 v94, v20, v21
    ds_write_addtid_b32 v79 offset:864
    ds_write_addtid_b32 v82 offset:2016
    ds_write_addtid_b32 v83 offset:2304
    ds_write_addtid_b32 v94 offset:2592
    v_pk_fma_f32 v[86:87], v[138:139], v[40:41], v[74:75] op_sel:[1,1,0] op_sel_hi:[1,0,1] neg_lo:[0,1,0]
    v_pk_mul_f32 v[88:89], v[20:21], v[40:41] op_sel_hi:[0,1]
    v_cvt_pk_bf16_f32 v95, v86, v87
    v_pk_fma_f32 v[96:97], v[20:21], v[40:41], v[88:89] op_sel:[1,1,0] op_sel_hi:[1,0,1] neg_lo:[0,1,0]
    v_pk_mul_f32 v[98:99], v[86:87], v[40:41] op_sel_hi:[0,1]
    v_cvt_pk_bf16_f32 v85, v96, v97
    ds_write_addtid_b32 v95 offset:2880
    v_pk_fma_f32 v[72:73], v[86:87], v[40:41], v[98:99] op_sel:[1,1,0] op_sel_hi:[1,0,1] neg_lo:[0,1,0]
    v_pk_mul_f32 v[104:105], v[96:97], v[40:41] op_sel_hi:[0,1]
    ds_write_addtid_b32 v85 offset:3168
    v_pk_fma_f32 v[118:119], v[96:97], v[40:41], v[104:105] op_sel:[1,1,0] op_sel_hi:[1,0,1] neg_lo:[0,1,0]
    v_cvt_pk_bf16_f32 v81, v72, v73
    v_cvt_pk_bf16_f32 v90, v118, v119
    v_pk_mul_f32 v[92:93], v[72:73], v[40:41] op_sel_hi:[0,1]
    v_pk_mul_f32 v[136:137], v[118:119], v[40:41] op_sel_hi:[0,1]
    ds_write_addtid_b32 v81 offset:3456
    ds_write_addtid_b32 v90 offset:3744
    v_pk_fma_f32 v[18:19], v[72:73], v[40:41], v[92:93] op_sel:[1,1,0] op_sel_hi:[1,0,1] neg_lo:[0,1,0]
    v_pk_fma_f32 v[16:17], v[118:119], v[40:41], v[136:137] op_sel:[1,1,0] op_sel_hi:[1,0,1] neg_lo:[0,1,0]
    v_cvt_pk_bf16_f32 v24, v18, v19
    v_cvt_pk_bf16_f32 v25, v16, v17
    v_pk_mul_f32 v[22:23], v[50:51], v[54:55] op_sel_hi:[0,1]
    v_pk_mul_f32 v[48:49], v[50:51], v[42:43] op_sel_hi:[0,1]
    ds_write_addtid_b32 v24 offset:4032
    ds_write_addtid_b32 v25 offset:4320
    ds_read_b128 v[100:103], v13 offset:0
    ds_read_b128 v[106:109], v13 offset:64
    ds_read_b128 v[60:63], v13 offset:128
    ds_read_b128 v[112:115], v13 offset:192
    v_pk_fma_f32 v[56:57], v[50:51], v[54:55], v[22:23] op_sel:[1,1,0] op_sel_hi:[1,0,1] neg_lo:[0,1,0]
    v_pk_fma_f32 v[52:53], v[50:51], v[42:43], v[48:49] op_sel:[1,1,0] op_sel_hi:[1,0,1] neg_lo:[0,1,0]
    v_pk_mul_f32 v[66:67], v[56:57], v[42:43] op_sel_hi:[0,1]
    v_pk_mul_f32 v[116:117], v[52:53], v[42:43] op_sel_hi:[0,1]
    v_pk_fma_f32 v[120:121], v[56:57], v[42:43], v[66:67] op_sel:[1,1,0] op_sel_hi:[1,0,1] neg_lo:[0,1,0]
    v_pk_fma_f32 v[122:123], v[52:53], v[42:43], v[116:117] op_sel:[1,1,0] op_sel_hi:[1,0,1] neg_lo:[0,1,0]
    v_pk_mul_f32 v[110:111], v[120:121], v[42:43] op_sel_hi:[0,1]
    v_pk_mul_f32 v[58:59], v[122:123], v[42:43] op_sel_hi:[0,1]
    v_pk_fma_f32 v[38:39], v[120:121], v[42:43], v[110:111] op_sel:[1,1,0] op_sel_hi:[1,0,1] neg_lo:[0,1,0]
    v_pk_fma_f32 v[68:69], v[122:123], v[42:43], v[58:59] op_sel:[1,1,0] op_sel_hi:[1,0,1] neg_lo:[0,1,0]
    v_pk_mul_f32 v[76:77], v[38:39], v[42:43] op_sel_hi:[0,1]
    v_pk_mul_f32 v[64:65], v[50:51], v[40:41] op_sel_hi:[0,1]
    v_pk_fma_f32 v[70:71], v[38:39], v[42:43], v[76:77] op_sel:[1,1,0] op_sel_hi:[1,0,1] neg_lo:[0,1,0]
    v_pk_fma_f32 v[78:79], v[50:51], v[40:41], v[64:65] op_sel:[1,1,0] op_sel_hi:[1,0,1] neg_lo:[0,1,0]
    v_pk_mul_f32 v[82:83], v[56:57], v[40:41] op_sel_hi:[0,1]
    v_pk_mul_f32 v[74:75], v[52:53], v[40:41] op_sel_hi:[0,1]
    v_pk_fma_f32 v[138:139], v[56:57], v[40:41], v[82:83] op_sel:[1,1,0] op_sel_hi:[1,0,1] neg_lo:[0,1,0]
    v_pk_fma_f32 v[20:21], v[52:53], v[40:41], v[74:75] op_sel:[1,1,0] op_sel_hi:[1,0,1] neg_lo:[0,1,0]
    v_pk_mul_f32 v[88:89], v[120:121], v[40:41] op_sel_hi:[0,1]
    v_pk_mul_f32 v[94:95], v[122:123], v[40:41] op_sel_hi:[0,1]
    v_pk_fma_f32 v[86:87], v[120:121], v[40:41], v[88:89] op_sel:[1,1,0] op_sel_hi:[1,0,1] neg_lo:[0,1,0]
    v_pk_fma_f32 v[98:99], v[122:123], v[40:41], v[94:95] op_sel:[1,1,0] op_sel_hi:[1,0,1] neg_lo:[0,1,0]
    v_pk_mul_f32 v[84:85], v[38:39], v[40:41] op_sel_hi:[0,1]
    s_waitcnt lgkmcnt(0)
    v_mfma_f32_16x16x32_bf16 v[128:131], v[100:103], v[26:29], 0
    v_cvt_pk_bf16_f32 v91, v50, v51
    v_mfma_f32_16x16x32_bf16 v[128:131], v[106:109], v[34:37], v[128:131]
    v_cvt_pk_bf16_f32 v80, v78, v79
    v_mfma_f32_16x16x32_bf16 v[128:131], v[60:63], v[44:47], v[128:131]
    ds_write_addtid_b32 v91 offset:0
    v_mfma_f32_16x16x32_bf16 v[128:131], v[112:115], v[30:33], v[128:131]
    ds_write_addtid_b32 v80 offset:2304
    v_cvt_pk_bf16_f32 v96, v56, v57
    v_cvt_pk_bf16_f32 v97, v138, v139
    v_cvt_pk_bf16_f32 v104, v52, v53
    v_cvt_pk_bf16_f32 v105, v20, v21
    ds_write_addtid_b32 v96 offset:288
    ds_write_addtid_b32 v97 offset:2592
    ds_write_addtid_b32 v104 offset:576
    ds_write_addtid_b32 v105 offset:2880
    v_cvt_pk_bf16_f32 v81, v120, v121
    v_cvt_pk_bf16_f32 v90, v86, v87
    v_cvt_pk_bf16_f32 v72, v122, v123
    v_cvt_pk_bf16_f32 v73, v98, v99
    ds_write_addtid_b32 v81 offset:864
    ds_write_addtid_b32 v90 offset:3168
    ds_write_addtid_b32 v72 offset:1152
    ds_write_addtid_b32 v73 offset:3456
    v_cvt_pk_bf16_f32 v92, v38, v39
    v_pk_fma_f32 v[118:119], v[38:39], v[40:41], v[84:85] op_sel:[1,1,0] op_sel_hi:[1,0,1] neg_lo:[0,1,0]
    v_cvt_pk_bf16_f32 v93, v68, v69
    v_cvt_pk_bf16_f32 v136, v118, v119
    ds_write_addtid_b32 v92 offset:1440
    v_pk_mul_f32 v[18:19], v[68:69], v[40:41] op_sel_hi:[0,1]
    ds_write_addtid_b32 v93 offset:1728
    ds_write_addtid_b32 v136 offset:3744
    v_pk_fma_f32 v[16:17], v[68:69], v[40:41], v[18:19] op_sel:[1,1,0] op_sel_hi:[1,0,1] neg_lo:[0,1,0]
    v_cvt_pk_bf16_f32 v137, v70, v71
    v_cvt_pk_bf16_f32 v24, v16, v17
L_pollA:
    ds_read_b32 v14, v15
    s_waitcnt lgkmcnt(0)
    v_readfirstlane_b32 s13, v14
    s_nop 3
    s_cmp_eq_u32 s13, 0
    s_cbranch_scc1 L_pollA
    ds_read_b128 v[64:67], v166 offset:2048
    ds_read_b128 v[74:77], v166 offset:1024
    ds_write_addtid_b32 v24 offset:4032
    ds_write_addtid_b32 v137 offset:2016
    v_pk_mul_f32 v[22:23], v[70:71], v[40:41] op_sel_hi:[0,1]
    v_pk_fma_f32 v[54:55], v[70:71], v[40:41], v[22:23] op_sel:[1,1,0] op_sel_hi:[1,0,1] neg_lo:[0,1,0]
    v_cvt_pk_bf16_f32 v25, v54, v55
    ds_write_addtid_b32 v25 offset:4320
    ds_read_b128 v[100:103], v13 offset:0
    ds_read_b128 v[48:51], v13 offset:64
    ds_read_b128 v[106:109], v13 offset:128
    ds_read_b128 v[58:61], v13 offset:192
    s_waitcnt lgkmcnt(8)
    v_pk_add_f32 v[132:133], v[132:133], v[64:65]
    v_pk_add_f32 v[134:135], v[134:135], v[66:67]
    v_cvt_pk_bf16_f32 v116, v132, v132
    v_cvt_pk_bf16_f32 v117, v132, v132
    v_cvt_pk_bf16_f32 v110, v133, v133
    v_cvt_pk_bf16_f32 v111, v133, v133
    v_cvt_pk_bf16_f32 v42, v134, v134
    ds_write2_b64 v156, v[116:117], v[116:117] offset0:0 offset1:1
    v_cvt_pk_bf16_f32 v43, v134, v134
    ds_write2_b64 v157, v[110:111], v[110:111] offset0:32 offset1:33
    v_cvt_pk_bf16_f32 v82, v135, v135
    v_cvt_pk_bf16_f32 v83, v135, v135
    ds_write2_b64 v157, v[42:43], v[42:43] offset0:64 offset1:65
    s_waitcnt lgkmcnt(10)
    v_pk_add_f32 v[128:129], v[128:129], v[74:75]
    ds_write2_b64 v157, v[82:83], v[82:83] offset0:96 offset1:97
    ds_write_b16 v158, v116 offset:16
    ds_write_b16 v158, v110 offset:272
    ds_write_b16 v158, v42 offset:528
    ds_write_b16 v158, v82 offset:784
    v_pk_add_f32 v[130:131], v[130:131], v[76:77]
    v_cvt_pk_bf16_f32 v112, v128, v128
    v_cvt_pk_bf16_f32 v113, v129, v130
    v_cvt_pk_bf16_f32 v114, v130, v130
    s_waitcnt lgkmcnt(8)
    v_mfma_f32_16x16x32_bf16 v[124:127], v[100:103], v[26:29], 0
    v_cvt_pk_bf16_f32 v115, v131, v131
    v_mfma_f32_16x16x32_bf16 v[124:127], v[48:51], v[34:37], v[124:127]
    v_cvt_pk_bf16_f32 v88, v128, v129
    v_mfma_f32_16x16x32_bf16 v[124:127], v[106:109], v[44:47], v[124:127]
    ds_write2_b32 v159, v112, v112 offset1:1
    v_mfma_f32_16x16x32_bf16 v[124:127], v[58:61], v[30:33], v[124:127]
    v_cvt_pk_bf16_f32 v89, v129, v129
    v_cvt_pk_bf16_f32 v94, v130, v131
    ds_write2_b32 v159, v88, v89 offset0:2 offset1:3
    ds_write2_b32 v159, v114, v114 offset0:64 offset1:65
    ds_write2_b32 v159, v94, v115 offset0:66 offset1:67
    ds_write_b128 v160, v[112:115]
    ds_write_b16 v161, v112
    s_branch L_hf0
L_kgenB:
    s_setprio 1
    v_mul_f32 v16, v12, v5
    v_mul_f32 v17, v11, v4
    v_fma_f32 v18, v5, v12, -v16
    v_pk_mul_f32 v[20:21], v[6:7], v[10:11] op_sel_hi:[1,0]
    v_fmac_f32 v18, v3, v5
    v_mul_f32 v19, 0x41000000, v16
    v_mul_f32 v22, 0x41000000, v17
    v_rndne_f32 v23, v19
    v_exp_f32 v24, v22
    v_sub_f32 v25, v19, v23
    v_mul_f32 v26, 0x43000000, v16
    v_fmac_f32 v25, 0x41000000, v18
    v_mul_f32 v27, 0x43000000, v17
    v_cos_f32 v28, v25
    v_sin_f32 v29, v25
    v_rndne_f32 v30, v26
    v_mul_f32 v32, v24, v28
    v_mul_f32_e64 v33, -v24, v29
    v_exp_f32 v31, v27
    v_sub_f32 v34, v26, v30
    v_mov_b32 v35, 0x3f80
    v_fmac_f32 v34, 0x43000000, v18
    v_pk_mul_f32 v[36:37], v[32:33], v[32:33] op_sel_hi:[0,1]
    v_cos_f32 v38, v34
    ds_write_addtid_b32 v35 offset:0
    v_sin_f32 v39, v34
    v_mul_f32 v40, v31, v38
    v_pk_fma_f32 v[42:43], v[32:33], v[32:33], v[36:37] op_sel:[1,1,0] op_sel_hi:[1,0,1] neg_lo:[0,1,0]
    v_mul_f32 v41, v31, v39
    v_cvt_pk_bf16_f32 v44, v32, v33
    v_cvt_pk_bf16_f32 v45, v42, v43
    v_pk_mul_f32 v[46:47], v[8:9], v[20:21] op_sel_hi:[0,1]
    v_pk_mul_f32 v[48:49], v[32:33], v[42:43] op_sel_hi:[0,1]
    ds_write_addtid_b32 v44 offset:288
    ds_write_addtid_b32 v45 offset:576
    v_pk_fma_f32 v[50:51], v[8:9], v[20:21], v[46:47] op_sel:[1,1,0] op_sel_hi:[1,0,1] neg_lo:[0,1,0]
    v_pk_fma_f32 v[52:53], v[32:33], v[42:43], v[48:49] op_sel:[1,1,0] op_sel_hi:[1,0,1] neg_lo:[0,1,0]
    v_pk_mul_f32 v[54:55], v[42:43], v[42:43] op_sel_hi:[0,1]
    v_cvt_pk_bf16_f32 v56, v52, v53
    v_pk_fma_f32 v[58:59], v[42:43], v[42:43], v[54:55] op_sel:[1,1,0] op_sel_hi:[1,0,1] neg_lo:[0,1,0]
    v_pk_mul_f32 v[60:61], v[52:53], v[42:43] op_sel_hi:[0,1]
    v_cvt_pk_bf16_f32 v57, v58, v59
    ds_write_addtid_b32 v56 offset:864
    v_pk_fma_f32 v[62:63], v[52:53], v[42:43], v[60:61] op_sel:[1,1,0] op_sel_hi:[1,0,1] neg_lo:[0,1,0]
    v_pk_mul_f32 v[64:65], v[58:59], v[42:43] op_sel_hi:[0,1]
    ds_write_addtid_b32 v57 offset:1152
    v_cvt_pk_bf16_f32 v66, v62, v63
    v_pk_fma_f32 v[68:69], v[58:59], v[42:43], v[64:65] op_sel:[1,1,0] op_sel_hi:[1,0,1] neg_lo:[0,1,0]
    v_pk_mul_f32 v[70:71], v[40:41], v[40:41] op_sel_hi:[0,1]
    v_cvt_pk_bf16_f32 v67, v68, v69
    ds_write_addtid_b32 v66 offset:1440
    v_pk_fma_f32 v[72:73], v[40:41], v[40:41], v[70:71] op_sel:[1,1,0] op_sel_hi:[1,0,1] neg_lo:[0,1,0]
    v_pk_mul_f32 v[74:75], v[62:63], v[42:43] op_sel_hi:[0,1]
    ds_write_addtid_b32 v67 offset:1728
    v_pk_fma_f32 v[76:77], v[62:63], v[42:43], v[74:75] op_sel:[1,1,0] op_sel_hi:[1,0,1] neg_lo:[0,1,0]
    v_pk_mul_f32 v[78:79], v[68:69], v[42:43] op_sel_hi:[0,1]
    v_cvt_pk_bf16_f32 v80, v76, v77
    v_pk_fma_f32 v[82:83], v[68:69], v[42:43], v[78:79] op_sel:[1,1,0] op_sel_hi:[1,0,1] neg_lo:[0,1,0]
    v_pk_mul_f32 v[84:85], v[76:77], v[42:43] op_sel_hi:[0,1]
    v_cvt_pk_bf16_f32 v81, v82, v83
    ds_write_addtid_b32 v80 offset:2016
    v_pk_fma_f32 v[86:87], v[76:77], v[42:43], v[84:85] op_sel:[1,1,0] op_sel_hi:[1,0,1] neg_lo:[0,1,0]
    v_pk_mul_f32 v[88:89], v[72:73], v[72:73] op_sel_hi:[0,1]
    ds_write_addtid_b32 v81 offset:2304
    v_cvt_pk_bf16_f32 v90, v86, v87
    v_pk_fma_f32 v[92:93], v[72:73], v[72:73], v[88:89] op_sel:[1,1,0] op_sel_hi:[1,0,1] neg_lo:[0,1,0]
    v_pk_mul_f32 v[94:95], v[82:83], v[42:43] op_sel_hi:[0,1]
    v_pk_mul_f32 v[96:97], v[86:87], v[42:43] op_sel_hi:[0,1]
    ds_write_addtid_b32 v90 offset:2592
    v_pk_fma_f32 v[98:99], v[82:83], v[42:43], v[94:95] op_sel:[1,1,0] op_sel_hi:[1,0,1] neg_lo:[0,1,0]
    v_pk_fma_f32 v[100:101], v[86:87], v[42:43], v[96:97] op_sel:[1,1,0] op_sel_hi:[1,0,1] neg_lo:[0,1,0]
    v_cvt_pk_bf16_f32 v91, v98, v99
    v_cvt_pk_bf16_f32 v102, v100, v101
    v_pk_mul_f32 v[104:105], v[98:99], v[42:43] op_sel_hi:[0,1]
    v_pk_mul_f32 v[106:107], v[92:93], v[92:93] op_sel_hi:[0,1]
    ds_write_addtid_b32 v91 offset:2880
    ds_write_addtid_b32 v102 offset:3168
    v_pk_fma_f32 v[108:109], v[98:99], v[42:43], v[104:105] op_sel:[1,1,0] op_sel_hi:[1,0,1] neg_lo:[0,1,0]
    v_pk_fma_f32 v[110:111], v[92:93], v[92:93], v[106:107] op_sel:[1,1,0] op_sel_hi:[1,0,1] neg_lo:[0,1,0]
    v_cvt_pk_bf16_f32 v103, v108, v109
    v_pk_mul_f32 v[112:113], v[100:101], v[42:43] op_sel_hi:[0,1]
    v_pk_mul_f32 v[114:115], v[108:109], v[42:43] op_sel_hi:[0,1]
    v_pk_fma_f32 v[116:117], v[100:101], v[42:43], v[112:113] op_sel:[1,1,0] op_sel_hi:[1,0,1] neg_lo:[0,1,0]
    ds_write_addtid_b32 v103 offset:3456
    v_cvt_pk_bf16_f32 v118, v116, v117
    v_pk_fma_f32 v[120:121], v[108:109], v[42:43], v[114:115] op_sel:[1,1,0] op_sel_hi:[1,0,1] neg_lo:[0,1,0]
    v_pk_mul_f32 v[122:123], v[116:117], v[42:43] op_sel_hi:[0,1]
    v_cvt_pk_bf16_f32 v119, v120, v121
    ds_write_addtid_b32 v118 offset:3744
    v_pk_fma_f32 v[136:137], v[116:117], v[42:43], v[122:123] op_sel:[1,1,0] op_sel_hi:[1,0,1] neg_lo:[0,1,0]
    v_rndne_f32 v138, v16
    ds_write_addtid_b32 v119 offset:4032
    v_cvt_pk_bf16_f32 v139, v136, v137
    v_exp_f32 v22, v17
    v_sub_f32 v19, v16, v138
    v_pk_mul_f32 v[24:25], v[50:51], v[110:111] op_sel_hi:[0,1]
    ds_write_addtid_b32 v139 offset:4320
    ds_read_b128 v[26:29], v13 offset:0
    ds_read_b128 v[34:37], v13 offset:64
    ds_read_b128 v[44:47], v13 offset:128
    ds_read_b128 v[30:33], v13 offset:192
    v_add_f32 v23, v19, v18
    v_pk_fma_f32 v[38:39], v[50:51], v[110:111], v[24:25] op_sel:[1,1,0] op_sel_hi:[1,0,1] neg_lo:[0,1,0]
    v_cos_f32 v20, v23
    v_sin_f32 v21, v23
    v_pk_mul_f32 v[48:49], v[38:39], v[40:41] op_sel_hi:[0,1]
    v_mul_f32 v54, v22, v20
    v_mul_f32 v55, v22, v21
    v_pk_fma_f32 v[52:53], v[38:39], v[40:41], v[48:49] op_sel:[1,1,0] op_sel_hi:[1,0,1] neg_lo:[0,1,0]
    v_cvt_pk_bf16_f32 v56, v38, v39
    v_pk_mul_f32 v[60:61], v[38:39], v[72:73] op_sel_hi:[0,1]
    v_cvt_pk_bf16_f32 v57, v52, v53
    v_pk_fma_f32 v[58:59], v[38:39], v[72:73], v[60:61] op_sel:[1,1,0] op_sel_hi:[1,0,1] neg_lo:[0,1,0]
    ds_write_addtid_b32 v56 offset:0
    v_pk_mul_f32 v[64:65], v[52:53], v[72:73] op_sel_hi:[0,1]
    ds_write_addtid_b32 v57 offset:288
    v_pk_fma_f32 v[70:71], v[52:53], v[72:73], v[64:65] op_sel:[1,1,0] op_sel_hi:[1,0,1] neg_lo:[0,1,0]
    v_cvt_pk_bf16_f32 v66, v58, v59
    v_pk_mul_f32 v[62:63], v[58:59], v[72:73] op_sel_hi:[0,1]
    v_cvt_pk_bf16_f32 v67, v70, v71
    v_pk_fma_f32 v[74:75], v[58:59], v[72:73], v[62:63] op_sel:[1,1,0] op_sel_hi:[1,0,1] neg_lo:[0,1,0]
    ds_write_addtid_b32 v66 offset:576
    v_pk_mul_f32 v[68:69], v[70:71], v[72:73] op_sel_hi:[0,1]
    ds_write_addtid_b32 v67 offset:864
    v_pk_fma_f32 v[78:79], v[70:71], v[72:73], v[68:69] op_sel:[1,1,0] op_sel_hi:[1,0,1] neg_lo:[0,1,0]
    v_cvt_pk_bf16_f32 v80, v74, v75
    v_pk_mul_f32 v[76:77], v[74:75], v[72:73] op_sel_hi:[0,1]
    v_cvt_pk_bf16_f32 v84, v78, v79
    v_pk_fma_f32 v[88:89], v[74:75], v[72:73], v[76:77] op_sel:[1,1,0] op_sel_hi:[1,0,1] neg_lo:[0,1,0]
    ds_write_addtid_b32 v80 offset:1152
    v_pk_mul_f32 v[82:83], v[78:79], v[72:73] op_sel_hi:[0,1]
    ds_write_addtid_b32 v84 offset:1440
    v_pk_fma_f32 v[94:95], v[78:79], v[72:73], v[82:83] op_sel:[1,1,0] op_sel_hi:[1,0,1] neg_lo:[0,1,0]
    v_cvt_pk_bf16_f32 v85, v88, v89
    v_pk_mul_f32 v[86:87], v[88:89], v[72:73] op_sel_hi:[0,1]
    v_cvt_pk_bf16_f32 v81, v94, v95
    v_pk_fma_f32 v[96:97], v[88:89], v[72:73], v[86:87] op_sel:[1,1,0] op_sel_hi:[1,0,1] neg_lo:[0,1,0]
    ds_write_addtid_b32 v85 offset:1728
    v_cvt_pk_bf16_f32 v90, v96, v97
    ds_write_addtid_b32 v81 offset:2016
    v_pk_mul_f32 v[98:99], v[54:55], v[54:55] op_sel_hi:[0,1]
    v_pk_mul_f32 v[104:105], v[50:51], v[72:73] op_sel_hi:[0,1]
    ds_write_addtid_b32 v90 offset:2304
    ds_read_b128 v[100:103], v13 offset:0
    ds_read_b128 v[106:109], v13 offset:64
    ds_read_b128 v[112:115], v13 offset:128
    ds_read_b128 v[120:123], v13 offset:192
    v_pk_fma_f32 v[42:43], v[54:55], v[54:55], v[98:99] op_sel:[1,1,0] op_sel_hi:[1,0,1] neg_lo:[0,1,0]
    v_pk_fma_f32 v[116:117], v[50:51], v[72:73], v[104:105] op_sel:[1,1,0] op_sel_hi:[1,0,1] neg_lo:[0,1,0]
    v_pk_mul_f32 v[118:119], v[42:43], v[42:43] op_sel_hi:[0,1]
    v_pk_mul_f32 v[136:137], v[50:51], v[92:93] op_sel_hi:[0,1]
    v_pk_fma_f32 v[16:17], v[42:43], v[42:43], v[118:119] op_sel:[1,1,0] op_sel_hi:[1,0,1] neg_lo:[0,1,0]
    v_pk_fma_f32 v[138:139], v[50:51], v[92:93], v[136:137] op_sel:[1,1,0] op_sel_hi:[1,0,1] neg_lo:[0,1,0]
    v_pk_mul_f32 v[18:19], v[116:117], v[42:43] op_sel_hi:[0,1]
    v_pk_mul_f32 v[24:25], v[138:139], v[16:17] op_sel_hi:[0,1]
    v_pk_fma_f32 v[110:111], v[116:117], v[42:43], v[18:19] op_sel:[1,1,0] op_sel_hi:[1,0,1] neg_lo:[0,1,0]
    v_pk_fma_f32 v[20:21], v[138:139], v[16:17], v[24:25] op_sel:[1,1,0] op_sel_hi:[1,0,1] neg_lo:[0,1,0]
    v_pk_mul_f32 v[22:23], v[110:111], v[42:43] op_sel_hi:[0,1]
    v_pk_mul_f32 v[48:49], v[116:117], v[40:41] op_sel_hi:[0,1]
    v_pk_fma_f32 v[38:39], v[110:111], v[42:43], v[22:23] op_sel:[1,1,0] op_sel_hi:[1,0,1] neg_lo:[0,1,0]
    v_pk_fma_f32 v[60:61], v[116:117], v[40:41], v[48:49] op_sel:[1,1,0] op_sel_hi:[1,0,1] neg_lo:[0,1,0]
    v_pk_mul_f32 v[56:57], v[38:39], v[42:43] op_sel_hi:[0,1]
    v_pk_mul_f32 v[52:53], v[110:111], v[40:41] op_sel_hi:[0,1]
    v_pk_fma_f32 v[64:65], v[38:39], v[42:43], v[56:57] op_sel:[1,1,0] op_sel_hi:[1,0,1] neg_lo:[0,1,0]
    v_pk_fma_f32 v[58:59], v[110:111], v[40:41], v[52:53] op_sel:[1,1,0] op_sel_hi:[1,0,1] neg_lo:[0,1,0]
    v_pk_mul_f32 v[62:63], v[38:39], v[40:41] op_sel_hi:[0,1]
    s_setprio 0
    v_pk_mul_f32 v[66:67], v[64:65], v[40:41] op_sel_hi:[0,1]
    v_pk_fma_f32 v[68:69], v[38:39], v[40:41], v[62:63] op_sel:[1,1,0] op_sel_hi:[1,0,1] neg_lo:[0,1,0]
    v_pk_fma_f32 v[70:71], v[64:65], v[40:41], v[66:67] op_sel:[1,1,0] op_sel_hi:[1,0,1] neg_lo:[0,1,0]
    v_pk_mul_f32 v[74:75], v[138:139], v[40:41] op_sel_hi:[0,1]
    s_waitcnt lgkmcnt(0)
    v_mfma_f32_16x16x32_bf16 v[132:135], v[100:103], v[26:29], 0
    v_cvt_pk_bf16_f32 v91, v116, v117
    v_mfma_f32_16x16x32_bf16 v[132:135], v[106:109], v[34:37], v[132:135]
    v_cvt_pk_bf16_f32 v76, v60, v61
    v_mfma_f32_16x16x32_bf16 v[132:135], v[112:115], v[44:47], v[132:135]
    ds_write_addtid_b32 v91 offset:0
    v_mfma_f32_16x16x32_bf16 v[132:135], v[120:123], v[30:33], v[132:135]
    ds_write_addtid_b32 v76 offset:1152
    v_cvt_pk_bf16_f32 v77, v110, v111
    v_cvt_pk_bf16_f32 v80, v58, v59
    v_cvt_pk_bf16_f32 v84, v38, v39
    v_cvt_pk_bf16_f32 v78, v68, v69
    ds_write_addtid_b32 v77 offset:288
    ds_write_addtid_b32 v80 offset:1440
    ds_write_addtid_b32 v84 offset:576
    ds_write_addtid_b32 v78 offset:1728
    ds_write_b128 v166, v[132:135] offset:2048
    v_cvt_pk_bf16_f32 v79, v64, v65
    v_cvt_pk_bf16_f32 v82, v70, v71
    v_cvt_pk_bf16_f32 v83, v138, v139
    v_cvt_pk_bf16_f32 v94, v20, v21
    ds_write_addtid_b32 v79 offset:864
    ds_write_addtid_b32 v82 offset:2016
    ds_write_addtid_b32 v83 offset:2304
    ds_write_addtid_b32 v94 offset:2592
    v_pk_fma_f32 v[86:87], v[138:139], v[40:41], v[74:75] op_sel:[1,1,0] op_sel_hi:[1,0,1] neg_lo:[0,1,0]
    v_pk_mul_f32 v[88:89], v[20:21], v[40:41] op_sel_hi:[0,1]
    v_cvt_pk_bf16_f32 v95, v86, v87
    v_pk_fma_f32 v[96:97], v[20:21], v[40:41], v[88:89] op_sel:[1,1,0] op_sel_hi:[1,0,1] neg_lo:[0,1,0]
    v_pk_mul_f32 v[98:99], v[86:87], v[40:41] op_sel_hi:[0,1]
    v_cvt_pk_bf16_f32 v85, v96, v97
    ds_write_addtid_b32 v95 offset:2880
    v_pk_fma_f32 v[72:73], v[86:87], v[40:41], v[98:99] op_sel:[1,1,0] op_sel_hi:[1,0,1] neg_lo:[0,1,0]
    v_pk_mul_f32 v[104:105], v[96:97], v[40:41] op_sel_hi:[0,1]
    ds_write_addtid_b32 v85 offset:3168
    v_pk_fma_f32 v[118:119], v[96:97], v[40:41], v[104:105] op_sel:[1,1,0] op_sel_hi:[1,0,1] neg_lo:[0,1,0]
    v_cvt_pk_bf16_f32 v81, v72, v73
    v_cvt_pk_bf16_f32 v90, v118, v119
    v_pk_mul_f32 v[92:93], v[72:73], v[40:41] op_sel_hi:[0,1]
    v_pk_mul_f32 v[136:137], v[118:119], v[40:41] op_sel_hi:[0,1]
    ds_write_addtid_b32 v81 offset:3456
    ds_write_addtid_b32 v90 offset:3744
    v_pk_fma_f32 v[18:19], v[72:73], v[40:41], v[92:93] op_sel:[1,1,0] op_sel_hi:[1,0,1] neg_lo:[0,1,0]
    v_pk_fma_f32 v[16:17], v[118:119], v[40:41], v[136:137] op_sel:[1,1,0] op_sel_hi:[1,0,1] neg_lo:[0,1,0]
    v_cvt_pk_bf16_f32 v24, v18, v19
    v_cvt_pk_bf16_f32 v25, v16, v17
    v_mov_b32 v22, 1
    v_pk_mul_f32 v[48:49], v[50:51], v[54:55] op_sel_hi:[0,1]
    ds_write_addtid_b32 v24 offset:4032
    ds_write_addtid_b32 v25 offset:4320
    ds_read_b128 v[100:103], v13 offset:0
    ds_read_b128 v[106:109], v13 offset:64
    ds_read_b128 v[60:63], v13 offset:128
    ds_read_b128 v[112:115], v13 offset:192
    v_pk_fma_f32 v[56:57], v[50:51], v[54:55], v[48:49] op_sel:[1,1,0] op_sel_hi:[1,0,1] neg_lo:[0,1,0]
    v_pk_mul_f32 v[52:53], v[50:51], v[42:43] op_sel_hi:[0,1]
    v_pk_mul_f32 v[66:67], v[56:57], v[42:43] op_sel_hi:[0,1]
    v_pk_fma_f32 v[116:117], v[50:51], v[42:43], v[52:53] op_sel:[1,1,0] op_sel_hi:[1,0,1] neg_lo:[0,1,0]
    v_pk_fma_f32 v[120:121], v[56:57], v[42:43], v[66:67] op_sel:[1,1,0] op_sel_hi:[1,0,1] neg_lo:[0,1,0]
    v_pk_mul_f32 v[122:123], v[116:117], v[42:43] op_sel_hi:[0,1]
    v_pk_mul_f32 v[110:111], v[120:121], v[42:43] op_sel_hi:[0,1]
    v_pk_fma_f32 v[58:59], v[116:117], v[42:43], v[122:123] op_sel:[1,1,0] op_sel_hi:[1,0,1] neg_lo:[0,1,0]
    v_pk_fma_f32 v[38:39], v[120:121], v[42:43], v[110:111] op_sel:[1,1,0] op_sel_hi:[1,0,1] neg_lo:[0,1,0]
    v_pk_mul_f32 v[68:69], v[58:59], v[42:43] op_sel_hi:[0,1]
    v_pk_mul_f32 v[76:77], v[38:39], v[42:43] op_sel_hi:[0,1]
    v_pk_fma_f32 v[64:65], v[58:59], v[42:43], v[68:69] op_sel:[1,1,0] op_sel_hi:[1,0,1] neg_lo:[0,1,0]
    v_pk_fma_f32 v[70:71], v[38:39], v[42:43], v[76:77] op_sel:[1,1,0] op_sel_hi:[1,0,1] neg_lo:[0,1,0]
    v_pk_mul_f32 v[78:79], v[50:51], v[40:41] op_sel_hi:[0,1]
    v_pk_mul_f32 v[82:83], v[56:57], v[40:41] op_sel_hi:[0,1]
    v_pk_fma_f32 v[74:75], v[50:51], v[40:41], v[78:79] op_sel:[1,1,0] op_sel_hi:[1,0,1] neg_lo:[0,1,0]
    v_pk_fma_f32 v[138:139], v[56:57], v[40:41], v[82:83] op_sel:[1,1,0] op_sel_hi:[1,0,1] neg_lo:[0,1,0]
    v_pk_mul_f32 v[20:21], v[116:117], v[40:41] op_sel_hi:[0,1]
    v_pk_mul_f32 v[88:89], v[120:121], v[40:41] op_sel_hi:[0,1]
    v_pk_fma_f32 v[94:95], v[116:117], v[40:41], v[20:21] op_sel:[1,1,0] op_sel_hi:[1,0,1] neg_lo:[0,1,0]
    v_pk_fma_f32 v[86:87], v[120:121], v[40:41], v[88:89] op_sel:[1,1,0] op_sel_hi:[1,0,1] neg_lo:[0,1,0]
    v_pk_mul_f32 v[98:99], v[58:59], v[40:41] op_sel_hi:[0,1]
    v_pk_mul_f32 v[84:85], v[38:39], v[40:41] op_sel_hi:[0,1]
    s_waitcnt lgkmcnt(0)
    v_mfma_f32_16x16x32_bf16 v[128:131], v[100:103], v[26:29], 0
    v_cvt_pk_bf16_f32 v23, v50, v51
    v_mfma_f32_16x16x32_bf16 v[128:131], v[106:109], v[34:37], v[128:131]
    v_cvt_pk_bf16_f32 v91, v74, v75
    v_mfma_f32_16x16x32_bf16 v[128:131], v[60:63], v[44:47], v[128:131]
    ds_write_addtid_b32 v23 offset:0
    v_mfma_f32_16x16x32_bf16 v[128:131], v[112:115], v[30:33], v[128:131]
    ds_write_addtid_b32 v91 offset:2304
    v_cvt_pk_bf16_f32 v80, v56, v57
    v_cvt_pk_bf16_f32 v96, v138, v139
    v_cvt_pk_bf16_f32 v97, v116, v117
    v_cvt_pk_bf16_f32 v104, v94, v95
    ds_write_addtid_b32 v80 offset:288
    ds_write_addtid_b32 v96 offset:2592
    ds_write_addtid_b32 v97 offset:576
    ds_write_addtid_b32 v104 offset:2880
    ds_write_b128 v166, v[128:131] offset:1024
    ds_write_b32 v15, v22
    v_cvt_pk_bf16_f32 v105, v120, v121
    v_cvt_pk_bf16_f32 v81, v86, v87
    v_cvt_pk_bf16_f32 v90, v58, v59
    v_pk_fma_f32 v[72:73], v[58:59], v[40:41], v[98:99] op_sel:[1,1,0] op_sel_hi:[1,0,1] neg_lo:[0,1,0]
    ds_write_addtid_b32 v105 offset:864
    ds_write_addtid_b32 v81 offset:3168
    ds_write_addtid_b32 v90 offset:1152
    v_cvt_pk_bf16_f32 v92, v72, v73
    v_cvt_pk_bf16_f32 v93, v38, v39
    v_pk_fma_f32 v[118:119], v[38:39], v[40:41], v[84:85] op_sel:[1,1,0] op_sel_hi:[1,0,1] neg_lo:[0,1,0]
    v_cvt_pk_bf16_f32 v136, v64, v65
    ds_write_addtid_b32 v92 offset:3456
    ds_write_addtid_b32 v93 offset:1440
    v_cvt_pk_bf16_f32 v137, v118, v119
    ds_write_addtid_b32 v136 offset:1728
    v_pk_mul_f32 v[18:19], v[64:65], v[40:41] op_sel_hi:[0,1]
    v_cvt_pk_bf16_f32 v16, v70, v71
    ds_write_addtid_b32 v137 offset:3744
    v_pk_fma_f32 v[24:25], v[64:65], v[40:41], v[18:19] op_sel:[1,1,0] op_sel_hi:[1,0,1] neg_lo:[0,1,0]
    v_pk_mul_f32 v[48:49], v[70:71], v[40:41] op_sel_hi:[0,1]
    ds_write_addtid_b32 v16 offset:2016
    v_cvt_pk_bf16_f32 v17, v24, v25
    v_pk_fma_f32 v[54:55], v[70:71], v[40:41], v[48:49] op_sel:[1,1,0] op_sel_hi:[1,0,1] neg_lo:[0,1,0]
    v_cvt_pk_bf16_f32 v52, v54, v55
    ds_write_addtid_b32 v17 offset:4032
    ds_write_addtid_b32 v52 offset:4320
    ds_read_b128 v[66:69], v13 offset:0
    ds_read_b128 v[76:79], v13 offset:64
    ds_read_b128 v[100:103], v13 offset:128
    ds_read_b128 v[106:109], v13 offset:192
    s_waitcnt lgkmcnt(0)
    v_mfma_f32_16x16x32_bf16 v[124:127], v[66:69], v[26:29], 0
    v_mfma_f32_16x16x32_bf16 v[124:127], v[76:79], v[34:37], v[124:127]
    v_mfma_f32_16x16x32_bf16 v[124:127], v[100:103], v[44:47], v[124:127]
    v_mfma_f32_16x16x32_bf16 v[124:127], v[106:109], v[30:33], v[124:127]
    s_nop 7
    ds_write_b128 v166, v[124:127]
    s_waitcnt lgkmcnt(0)
    s_barrier
    s_branch L_idle47
L_hf0:
    s_cmp_lg_u32 s7, 0
    s_cbranch_scc1 L_type2
    ds_read_b128 v[24:27], v164 offset:4032
    ds_read_b128 v[28:31], v164 offset:3520
    ds_read_b128 v[32:35], v164 offset:3008
    ds_read_b128 v[36:39], v164 offset:3968
    ds_read_b128 v[40:43], v164 offset:3456
    s_barrier
    s_setprio 2
    ds_read_b128 v[4:7], v166
    ds_read_b64 v[44:45], v163 offset:4032
    ds_read_b64 v[46:47], v163 offset:4040
    ds_read_b64 v[48:49], v163 offset:3520
    ds_read_b64 v[50:51], v163 offset:3528
    s_waitcnt lgkmcnt(4)
    v_pk_add_f32 v[124:125], v[124:125], v[4:5]
    v_pk_add_f32 v[126:127], v[126:127], v[6:7]
    v_add_f32 v124, v124, v167
    v_cvt_pk_bf16_f32 v5, v126, v127
    v_cvt_pk_bf16_f32 v4, v124, v125
    ds_write_b64 v162, v[4:5]
    ds_read_b128 v[52:55], v164 offset:960
    s_waitcnt lgkmcnt(4)
    v_mfma_f32_16x16x32_bf16 v[152:155], v[44:47], v[24:27], v[152:155]
    ds_read_b128 v[56:59], v164 offset:448
    v_mfma_f32_16x16x32_bf16 v[148:151], v[44:47], v[28:31], v[148:151]
    s_waitcnt lgkmcnt(3)
    v_mfma_f32_16x16x32_bf16 v[152:155], v[48:51], v[28:31], v[152:155]
    ds_read_b64 v[60:61], v163 offset:3968
    ds_read_b64 v[62:63], v163 offset:3976
    v_mfma_f32_16x16x32_bf16 v[148:151], v[48:51], v[32:35], v[148:151]
    s_waitcnt lgkmcnt(3)
    v_mfma_f32_16x16x32_bf16 v[144:147], v[44:47], v[52:55], v[144:147]
    ds_read_b64 v[64:65], v163 offset:3456
    ds_read_b64 v[66:67], v163 offset:3464
    s_waitcnt lgkmcnt(4)
    v_mfma_f32_16x16x32_bf16 v[140:143], v[44:47], v[56:59], v[140:143]
    ds_read_b128 v[68:71], v164 offset:2944
    v_mfma_f32_16x16x32_bf16 v[144:147], v[48:51], v[56:59], v[144:147]
    ds_read_b128 v[72:75], v164 offset:896
    s_waitcnt lgkmcnt(4)
    v_mfma_f32_16x16x32_bf16 v[152:155], v[60:63], v[36:39], v[152:155]
    ds_read_b128 v[76:79], v164 offset:384
    v_mfma_f32_16x16x32_bf16 v[148:151], v[60:63], v[40:43], v[148:151]
    s_waitcnt lgkmcnt(3)
    v_mfma_f32_16x16x32_bf16 v[152:155], v[64:67], v[40:43], v[152:155]
    ds_read_b64 v[80:81], v163 offset:3904
    ds_read_b64 v[82:83], v163 offset:3912
    ds_read_b128 v[84:87], v164 offset:3904
    s_waitcnt lgkmcnt(5)
    v_mfma_f32_16x16x32_bf16 v[148:151], v[64:67], v[68:71], v[148:151]
    ds_read_b128 v[88:91], v164 offset:3392
    s_waitcnt lgkmcnt(5)
    v_mfma_f32_16x16x32_bf16 v[144:147], v[60:63], v[72:75], v[144:147]
    ds_read_b64 v[92:93], v163 offset:3392
    ds_read_b64 v[94:95], v163 offset:3400
    s_waitcnt lgkmcnt(6)
    v_mfma_f32_16x16x32_bf16 v[140:143], v[60:63], v[76:79], v[140:143]
    ds_read_b128 v[96:99], v164 offset:2880
    v_mfma_f32_16x16x32_bf16 v[144:147], v[64:67], v[76:79], v[144:147]
    ds_read_b128 v[100:103], v164 offset:832
    s_waitcnt lgkmcnt(5)
    v_mfma_f32_16x16x32_bf16 v[152:155], v[80:83], v[84:87], v[152:155]
    ds_read_b128 v[104:107], v164 offset:320
    s_waitcnt lgkmcnt(5)
    v_mfma_f32_16x16x32_bf16 v[148:151], v[80:83], v[88:91], v[148:151]
    s_waitcnt lgkmcnt(3)
    v_mfma_f32_16x16x32_bf16 v[152:155], v[92:95], v[88:91], v[152:155]
    ds_read_b64 v[108:109], v163 offset:3840
    ds_read_b64 v[110:111], v163 offset:3848
    ds_read_b128 v[112:115], v164 offset:3840
    s_waitcnt lgkmcnt(5)
    v_mfma_f32_16x16x32_bf16 v[148:151], v[92:95], v[96:99], v[148:151]
    ds_read_b128 v[116:119], v164 offset:3328
    s_waitcnt lgkmcnt(5)
    v_mfma_f32_16x16x32_bf16 v[144:147], v[80:83], v[100:103], v[144:147]
    ds_read_b64 v[120:121], v163 offset:3328
    ds_read_b64 v[122:123], v163 offset:3336
    s_waitcnt lgkmcnt(6)
    v_mfma_f32_16x16x32_bf16 v[140:143], v[80:83], v[104:107], v[140:143]
    ds_read_b128 v[124:127], v164 offset:2816
    v_mfma_f32_16x16x32_bf16 v[144:147], v[92:95], v[104:107], v[144:147]
    ds_read_b128 v[128:131], v164 offset:768
    s_waitcnt lgkmcnt(5)
    v_mfma_f32_16x16x32_bf16 v[152:155], v[108:111], v[112:115], v[152:155]
    ds_read_b128 v[132:135], v164 offset:256
    s_waitcnt lgkmcnt(5)
    v_mfma_f32_16x16x32_bf16 v[148:151], v[108:111], v[116:119], v[148:151]
    s_waitcnt lgkmcnt(3)
    v_mfma_f32_16x16x32_bf16 v[152:155], v[120:123], v[116:119], v[152:155]
    ds_read_b64 v[136:137], v163 offset:3776
    ds_read_b64 v[138:139], v163 offset:3784
    ds_read_b128 v[24:27], v164 offset:3776
    s_waitcnt lgkmcnt(5)
    v_mfma_f32_16x16x32_bf16 v[148:151], v[120:123], v[124:127], v[148:151]
    ds_read_b128 v[28:31], v164 offset:3264
    s_waitcnt lgkmcnt(5)
    v_mfma_f32_16x16x32_bf16 v[144:147], v[108:111], v[128:131], v[144:147]
    ds_read_b64 v[32:33], v163 offset:3264
    ds_read_b64 v[34:35], v163 offset:3272
    s_waitcnt lgkmcnt(6)
    v_mfma_f32_16x16x32_bf16 v[140:143], v[108:111], v[132:135], v[140:143]
    ds_read_b128 v[52:55], v164 offset:2752
    v_mfma_f32_16x16x32_bf16 v[144:147], v[120:123], v[132:135], v[144:147]
    ds_read_b128 v[44:47], v164 offset:704
    s_waitcnt lgkmcnt(5)
    v_mfma_f32_16x16x32_bf16 v[152:155], v[136:139], v[24:27], v[152:155]
    ds_read_b128 v[48:51], v164 offset:192
    s_waitcnt lgkmcnt(5)
    v_mfma_f32_16x16x32_bf16 v[148:151], v[136:139], v[28:31], v[148:151]
    s_waitcnt lgkmcnt(3)
    v_mfma_f32_16x16x32_bf16 v[152:155], v[32:35], v[28:31], v[152:155]
    ds_read_b64 v[56:57], v163 offset:3712
    ds_read_b64 v[58:59], v163 offset:3720
    ds_read_b128 v[36:39], v164 offset:3712
    s_waitcnt lgkmcnt(5)
    v_mfma_f32_16x16x32_bf16 v[148:151], v[32:35], v[52:55], v[148:151]
    ds_read_b128 v[40:43], v164 offset:3200
    s_waitcnt lgkmcnt(5)
    v_mfma_f32_16x16x32_bf16 v[144:147], v[136:139], v[44:47], v[144:147]
    ds_read_b64 v[68:69], v163 offset:3200
    ds_read_b64 v[70:71], v163 offset:3208
    s_waitcnt lgkmcnt(6)
    v_mfma_f32_16x16x32_bf16 v[140:143], v[136:139], v[48:51], v[140:143]
    ds_read_b128 v[72:75], v164 offset:2688
    v_mfma_f32_16x16x32_bf16 v[144:147], v[32:35], v[48:51], v[144:147]
    ds_read_b128 v[60:63], v164 offset:640
    s_waitcnt lgkmcnt(5)
    v_mfma_f32_16x16x32_bf16 v[152:155], v[56:59], v[36:39], v[152:155]
    ds_read_b128 v[64:67], v164 offset:128
    s_waitcnt lgkmcnt(5)
    v_mfma_f32_16x16x32_bf16 v[148:151], v[56:59], v[40:43], v[148:151]
    s_waitcnt lgkmcnt(3)
    v_mfma_f32_16x16x32_bf16 v[152:155], v[68:71], v[40:43], v[152:155]
    ds_read_b64 v[76:77], v163 offset:3648
    ds_read_b64 v[78:79], v163 offset:3656
    ds_read_b128 v[84:87], v164 offset:3648
    s_waitcnt lgkmcnt(5)
    v_mfma_f32_16x16x32_bf16 v[148:151], v[68:71], v[72:75], v[148:151]
    ds_read_b128 v[88:91], v164 offset:3136
    s_waitcnt lgkmcnt(5)
    v_mfma_f32_16x16x32_bf16 v[144:147], v[56:59], v[60:63], v[144:147]
    ds_read_b64 v[96:97], v163 offset:3136
    ds_read_b64 v[98:99], v163 offset:3144
    s_waitcnt lgkmcnt(6)
    v_mfma_f32_16x16x32_bf16 v[140:143], v[56:59], v[64:67], v[140:143]
    ds_read_b128 v[100:103], v164 offset:2624
    v_mfma_f32_16x16x32_bf16 v[144:147], v[68:71], v[64:67], v[144:147]
    ds_read_b128 v[80:83], v164 offset:576
    s_waitcnt lgkmcnt(5)
    v_mfma_f32_16x16x32_bf16 v[152:155], v[76:79], v[84:87], v[152:155]
    ds_read_b128 v[92:95], v164 offset:64
    s_waitcnt lgkmcnt(5)
    v_mfma_f32_16x16x32_bf16 v[148:151], v[76:79], v[88:91], v[148:151]
    s_waitcnt lgkmcnt(3)
    v_mfma_f32_16x16x32_bf16 v[152:155], v[96:99], v[88:91], v[152:155]
    ds_read_b64 v[104:105], v163 offset:3584
    ds_read_b64 v[106:107], v163 offset:3592
    ds_read_b128 v[112:115], v164 offset:3584
    s_waitcnt lgkmcnt(5)
    v_mfma_f32_16x16x32_bf16 v[148:151], v[96:99], v[100:103], v[148:151]
    ds_read_b128 v[116:119], v164 offset:3072
    s_waitcnt lgkmcnt(5)
    v_mfma_f32_16x16x32_bf16 v[144:147], v[76:79], v[80:83], v[144:147]
    ds_read_b64 v[124:125], v163 offset:3072
    ds_read_b64 v[126:127], v163 offset:3080
    s_waitcnt lgkmcnt(6)
    v_mfma_f32_16x16x32_bf16 v[140:143], v[76:79], v[92:95], v[140:143]
    ds_read_b128 v[128:131], v164 offset:2560
    v_mfma_f32_16x16x32_bf16 v[144:147], v[96:99], v[92:95], v[144:147]
    ds_read_b128 v[108:111], v164 offset:512
    s_waitcnt lgkmcnt(5)
    v_mfma_f32_16x16x32_bf16 v[152:155], v[104:107], v[112:115], v[152:155]
    ds_read_b128 v[120:123], v164 offset:0
    s_waitcnt lgkmcnt(5)
    v_mfma_f32_16x16x32_bf16 v[148:151], v[104:107], v[116:119], v[148:151]
    s_waitcnt lgkmcnt(3)
    v_mfma_f32_16x16x32_bf16 v[152:155], v[124:127], v[116:119], v[152:155]
    s_waitcnt lgkmcnt(2)
    v_mfma_f32_16x16x32_bf16 v[148:151], v[124:127], v[128:131], v[148:151]
    s_waitcnt lgkmcnt(1)
    v_mfma_f32_16x16x32_bf16 v[144:147], v[104:107], v[108:111], v[144:147]
    s_waitcnt lgkmcnt(0)
    v_mfma_f32_16x16x32_bf16 v[140:143], v[104:107], v[120:123], v[140:143]
    v_mfma_f32_16x16x32_bf16 v[144:147], v[124:127], v[120:123], v[144:147]
    ds_read_b128 v[132:135], v164 offset:3008
    ds_read_b128 v[24:27], v164 offset:2496
    ds_read_b128 v[28:31], v164 offset:1984
    ds_read_b128 v[52:55], v164 offset:1472
    s_nop 3
    v_cvt_pk_bf16_f32 v8, v140, v141
    v_cvt_pk_bf16_f32 v9, v142, v143
    v_cvt_pk_bf16_f32 v10, v144, v145
    v_cvt_pk_bf16_f32 v11, v146, v147
    ds_write_b64 v165, v[8:9] offset:0
    ds_write_b64 v165, v[10:11] offset:512
    s_waitcnt lgkmcnt(0)
    s_barrier
    ds_read_b64 v[44:45], v163 offset:3008
    ds_read_b64 v[46:47], v163 offset:3016
    ds_read_b64 v[136:137], v163 offset:2496
    ds_read_b64 v[138:139], v163 offset:2504
    ds_read_b64 v[32:33], v163 offset:1984
    ds_read_b64 v[34:35], v163 offset:1992
    s_waitcnt lgkmcnt(4)
    v_mfma_f32_16x16x32_bf16 v[152:155], v[44:47], v[132:135], v[152:155]
    v_mfma_f32_16x16x32_bf16 v[148:151], v[44:47], v[24:27], v[148:151]
    ds_read_b64 v[48:49], v163 offset:1472
    ds_read_b64 v[50:51], v163 offset:1480
    s_waitcnt lgkmcnt(4)
    v_mfma_f32_16x16x32_bf16 v[152:155], v[136:139], v[24:27], v[152:155]
    ds_read_b128 v[36:39], v164 offset:960
    v_mfma_f32_16x16x32_bf16 v[148:151], v[136:139], v[28:31], v[148:151]
    ds_read_b64 v[40:41], v163 offset:960
    ds_read_b64 v[42:43], v163 offset:968
    s_waitcnt lgkmcnt(5)
    v_mfma_f32_16x16x32_bf16 v[152:155], v[32:35], v[28:31], v[152:155]
    ds_read_b128 v[72:75], v164 offset:448
    v_mfma_f32_16x16x32_bf16 v[148:151], v[32:35], v[52:55], v[148:151]
    ds_read_b64 v[60:61], v163 offset:448
    ds_read_b64 v[62:63], v163 offset:456
    s_waitcnt lgkmcnt(6)
    v_mfma_f32_16x16x32_bf16 v[152:155], v[48:51], v[52:55], v[152:155]
    ds_read_b64 v[56:57], v163 offset:2944
    ds_read_b64 v[58:59], v163 offset:2952
    ds_read_b128 v[68:71], v164 offset:2944
    s_waitcnt lgkmcnt(8)
    v_mfma_f32_16x16x32_bf16 v[148:151], v[48:51], v[36:39], v[148:151]
    ds_read_b128 v[64:67], v164 offset:2432
    s_waitcnt lgkmcnt(7)
    v_mfma_f32_16x16x32_bf16 v[152:155], v[40:43], v[36:39], v[152:155]
    ds_read_b64 v[84:85], v163 offset:2432
    ds_read_b64 v[86:87], v163 offset:2440
    s_waitcnt lgkmcnt(8)
    v_mfma_f32_16x16x32_bf16 v[148:151], v[40:43], v[72:75], v[148:151]
    ds_read_b128 v[88:91], v164 offset:1920
    s_waitcnt lgkmcnt(7)
    v_mfma_f32_16x16x32_bf16 v[152:155], v[60:63], v[72:75], v[152:155]
    ds_read_b64 v[100:101], v163 offset:1920
    ds_read_b64 v[102:103], v163 offset:1928
    s_waitcnt lgkmcnt(6)
    v_mfma_f32_16x16x32_bf16 v[152:155], v[56:59], v[68:71], v[152:155]
    ds_read_b128 v[80:83], v164 offset:1408
    s_waitcnt lgkmcnt(6)
    v_mfma_f32_16x16x32_bf16 v[148:151], v[56:59], v[64:67], v[148:151]
    ds_read_b64 v[76:77], v163 offset:1408
    ds_read_b64 v[78:79], v163 offset:1416
    s_waitcnt lgkmcnt(6)
    v_mfma_f32_16x16x32_bf16 v[152:155], v[84:87], v[64:67], v[152:155]
    ds_read_b128 v[96:99], v164 offset:896
    s_waitcnt lgkmcnt(6)
    v_mfma_f32_16x16x32_bf16 v[148:151], v[84:87], v[88:91], v[148:151]
    ds_read_b64 v[92:93], v163 offset:896
    ds_read_b64 v[94:95], v163 offset:904
    s_waitcnt lgkmcnt(6)
    v_mfma_f32_16x16x32_bf16 v[152:155], v[100:103], v[88:91], v[152:155]
    ds_read_b128 v[112:115], v164 offset:384
    s_waitcnt lgkmcnt(6)
    v_mfma_f32_16x16x32_bf16 v[148:151], v[100:103], v[80:83], v[148:151]
    ds_read_b64 v[104:105], v163 offset:384
    ds_read_b64 v[106:107], v163 offset:392
    s_waitcnt lgkmcnt(6)
    v_mfma_f32_16x16x32_bf16 v[152:155], v[76:79], v[80:83], v[152:155]
    ds_read_b64 v[116:117], v163 offset:2880
    ds_read_b64 v[118:119], v163 offset:2888
    ds_read_b128 v[124:127], v164 offset:2880
    s_waitcnt lgkmcnt(8)
    v_mfma_f32_16x16x32_bf16 v[148:151], v[76:79], v[96:99], v[148:151]
    ds_read_b128 v[128:131], v164 offset:2368
    s_waitcnt lgkmcnt(7)
    v_mfma_f32_16x16x32_bf16 v[152:155], v[92:95], v[96:99], v[152:155]
    ds_read_b64 v[108:109], v163 offset:2368
    ds_read_b64 v[110:111], v163 offset:2376
    s_waitcnt lgkmcnt(8)
    v_mfma_f32_16x16x32_bf16 v[148:151], v[92:95], v[112:115], v[148:151]
    ds_read_b128 v[120:123], v164 offset:1856
    s_waitcnt lgkmcnt(7)
    v_mfma_f32_16x16x32_bf16 v[152:155], v[104:107], v[112:115], v[152:155]
    ds_read_b64 v[132:133], v163 offset:1856
    ds_read_b64 v[134:135], v163 offset:1864
    s_waitcnt lgkmcnt(6)
    v_mfma_f32_16x16x32_bf16 v[152:155], v[116:119], v[124:127], v[152:155]
    ds_read_b128 v[44:47], v164 offset:1344
    s_waitcnt lgkmcnt(6)
    v_mfma_f32_16x16x32_bf16 v[148:151], v[116:119], v[128:131], v[148:151]
    ds_read_b64 v[24:25], v163 offset:1344
    ds_read_b64 v[26:27], v163 offset:1352
    s_waitcnt lgkmcnt(6)
    v_mfma_f32_16x16x32_bf16 v[152:155], v[108:111], v[128:131], v[152:155]
    ds_read_b128 v[136:139], v164 offset:832
    s_waitcnt lgkmcnt(6)
    v_mfma_f32_16x16x32_bf16 v[148:151], v[108:111], v[120:123], v[148:151]
    ds_read_b64 v[28:29], v163 offset:832
    ds_read_b64 v[30:31], v163 offset:840
    s_waitcnt lgkmcnt(6)
    v_mfma_f32_16x16x32_bf16 v[152:155], v[132:135], v[120:123], v[152:155]
    ds_read_b128 v[32:35], v164 offset:320
    s_waitcnt lgkmcnt(6)
    v_mfma_f32_16x16x32_bf16 v[148:151], v[132:135], v[44:47], v[148:151]
    ds_read_b64 v[52:53], v163 offset:320
    ds_read_b64 v[54:55], v163 offset:328
    s_waitcnt lgkmcnt(6)
    v_mfma_f32_16x16x32_bf16 v[152:155], v[24:27], v[44:47], v[152:155]
    ds_read_b64 v[48:49], v163 offset:2816
    ds_read_b64 v[50:51], v163 offset:2824
    ds_read_b128 v[36:39], v164 offset:2816
    s_waitcnt lgkmcnt(8)
    v_mfma_f32_16x16x32_bf16 v[148:151], v[24:27], v[136:139], v[148:151]
    ds_read_b128 v[40:43], v164 offset:2304
    s_waitcnt lgkmcnt(7)
    v_mfma_f32_16x16x32_bf16 v[152:155], v[28:31], v[136:139], v[152:155]
    ds_read_b64 v[72:73], v163 offset:2304
    ds_read_b64 v[74:75], v163 offset:2312
    s_waitcnt lgkmcnt(8)
    v_mfma_f32_16x16x32_bf16 v[148:151], v[28:31], v[32:35], v[148:151]
    ds_read_b128 v[60:63], v164 offset:1792
    s_waitcnt lgkmcnt(7)
    v_mfma_f32_16x16x32_bf16 v[152:155], v[52:55], v[32:35], v[152:155]
    ds_read_b64 v[68:69], v163 offset:1792
    ds_read_b64 v[70:71], v163 offset:1800
    s_waitcnt lgkmcnt(6)
    v_mfma_f32_16x16x32_bf16 v[152:155], v[48:51], v[36:39], v[152:155]
    ds_read_b128 v[56:59], v164 offset:1280
    s_waitcnt lgkmcnt(6)
    v_mfma_f32_16x16x32_bf16 v[148:151], v[48:51], v[40:43], v[148:151]
    ds_read_b64 v[64:65], v163 offset:1280
    ds_read_b64 v[66:67], v163 offset:1288
    s_waitcnt lgkmcnt(6)
    v_mfma_f32_16x16x32_bf16 v[152:155], v[72:75], v[40:43], v[152:155]
    ds_read_b128 v[84:87], v164 offset:768
    s_waitcnt lgkmcnt(6)
    v_mfma_f32_16x16x32_bf16 v[148:151], v[72:75], v[60:63], v[148:151]
    ds_read_b64 v[88:89], v163 offset:768
    ds_read_b64 v[90:91], v163 offset:776
    s_waitcnt lgkmcnt(6)
    v_mfma_f32_16x16x32_bf16 v[152:155], v[68:71], v[60:63], v[152:155]
    ds_read_b128 v[100:103], v164 offset:256
    s_waitcnt lgkmcnt(6)
    v_mfma_f32_16x16x32_bf16 v[148:151], v[68:71], v[56:59], v[148:151]
    ds_read_b64 v[80:81], v163 offset:256
    ds_read_b64 v[82:83], v163 offset:264
    s_waitcnt lgkmcnt(6)
    v_mfma_f32_16x16x32_bf16 v[152:155], v[64:67], v[56:59], v[152:155]
    ds_read_b64 v[76:77], v163 offset:2752
    ds_read_b64 v[78:79], v163 offset:2760
    ds_read_b128 v[96:99], v164 offset:2752
    s_waitcnt lgkmcnt(8)
    v_mfma_f32_16x16x32_bf16 v[148:151], v[64:67], v[84:87], v[148:151]
    ds_read_b128 v[92:95], v164 offset:2240
    s_waitcnt lgkmcnt(7)
    v_mfma_f32_16x16x32_bf16 v[152:155], v[88:91], v[84:87], v[152:155]
    ds_read_b64 v[112:113], v163 offset:2240
    ds_read_b64 v[114:115], v163 offset:2248
    s_waitcnt lgkmcnt(8)
    v_mfma_f32_16x16x32_bf16 v[148:151], v[88:91], v[100:103], v[148:151]
    ds_read_b128 v[104:107], v164 offset:1728
    s_waitcnt lgkmcnt(7)
    v_mfma_f32_16x16x32_bf16 v[152:155], v[80:83], v[100:103], v[152:155]
    ds_read_b64 v[124:125], v163 offset:1728
    ds_read_b64 v[126:127], v163 offset:1736
    s_waitcnt lgkmcnt(6)
    v_mfma_f32_16x16x32_bf16 v[152:155], v[76:79], v[96:99], v[152:155]
    ds_read_b128 v[116:119], v164 offset:1216
    s_waitcnt lgkmcnt(6)
    v_mfma_f32_16x16x32_bf16 v[148:151], v[76:79], v[92:95], v[148:151]
    ds_read_b64 v[128:129], v163 offset:1216
    ds_read_b64 v[130:131], v163 offset:1224
    s_waitcnt lgkmcnt(6)
    v_mfma_f32_16x16x32_bf16 v[152:155], v[112:115], v[92:95], v[152:155]
    ds_read_b128 v[108:111], v164 offset:704
    s_waitcnt lgkmcnt(6)
    v_mfma_f32_16x16x32_bf16 v[148:151], v[112:115], v[104:107], v[148:151]
    ds_read_b64 v[120:121], v163 offset:704
    ds_read_b64 v[122:123], v163 offset:712
    s_waitcnt lgkmcnt(6)
    v_mfma_f32_16x16x32_bf16 v[152:155], v[124:127], v[104:107], v[152:155]
    ds_read_b128 v[132:135], v164 offset:192
    s_waitcnt lgkmcnt(6)
    v_mfma_f32_16x16x32_bf16 v[148:151], v[124:127], v[116:119], v[148:151]
    ds_read_b64 v[44:45], v163 offset:192
    ds_read_b64 v[46:47], v163 offset:200
    s_waitcnt lgkmcnt(6)
    v_mfma_f32_16x16x32_bf16 v[152:155], v[128:131], v[116:119], v[152:155]
    ds_read_b64 v[24:25], v163 offset:2688
    ds_read_b64 v[26:27], v163 offset:2696
    ds_read_b128 v[136:139], v164 offset:2688
    s_waitcnt lgkmcnt(8)
    v_mfma_f32_16x16x32_bf16 v[148:151], v[128:131], v[108:111], v[148:151]
    ds_read_b128 v[28:31], v164 offset:2176
    s_waitcnt lgkmcnt(7)
    v_mfma_f32_16x16x32_bf16 v[152:155], v[120:123], v[108:111], v[152:155]
    ds_read_b64 v[32:33], v163 offset:2176
    ds_read_b64 v[34:35], v163 offset:2184
    s_waitcnt lgkmcnt(8)
    v_mfma_f32_16x16x32_bf16 v[148:151], v[120:123], v[132:135], v[148:151]
    ds_read_b128 v[52:55], v164 offset:1664
    s_waitcnt lgkmcnt(7)
    v_mfma_f32_16x16x32_bf16 v[152:155], v[44:47], v[132:135], v[152:155]
    ds_read_b64 v[36:37], v163 offset:1664
    ds_read_b64 v[38:39], v163 offset:1672
    s_waitcnt lgkmcnt(6)
    v_mfma_f32_16x16x32_bf16 v[152:155], v[24:27], v[136:139], v[152:155]
    ds_read_b128 v[48:51], v164 offset:1152
    s_waitcnt lgkmcnt(6)
    v_mfma_f32_16x16x32_bf16 v[148:151], v[24:27], v[28:31], v[148:151]
    ds_read_b64 v[40:41], v163 offset:1152
    ds_read_b64 v[42:43], v163 offset:1160
    s_waitcnt lgkmcnt(6)
    v_mfma_f32_16x16x32_bf16 v[152:155], v[32:35], v[28:31], v[152:155]
    ds_read_b128 v[72:75], v164 offset:640
    s_waitcnt lgkmcnt(6)
    v_mfma_f32_16x16x32_bf16 v[148:151], v[32:35], v[52:55], v[148:151]
    ds_read_b64 v[60:61], v163 offset:640
    ds_read_b64 v[62:63], v163 offset:648
    s_waitcnt lgkmcnt(6)
    v_mfma_f32_16x16x32_bf16 v[152:155], v[36:39], v[52:55], v[152:155]
    ds_read_b128 v[68:71], v164 offset:128
    s_waitcnt lgkmcnt(6)
    v_mfma_f32_16x16x32_bf16 v[148:151], v[36:39], v[48:51], v[148:151]
    ds_read_b64 v[56:57], v163 offset:128
    ds_read_b64 v[58:59], v163 offset:136
    s_waitcnt lgkmcnt(6)
    v_mfma_f32_16x16x32_bf16 v[152:155], v[40:43], v[48:51], v[152:155]
    ds_read_b64 v[64:65], v163 offset:2624
    ds_read_b64 v[66:67], v163 offset:2632
    ds_read_b128 v[84:87], v164 offset:2624
    s_waitcnt lgkmcnt(8)
    v_mfma_f32_16x16x32_bf16 v[148:151], v[40:43], v[72:75], v[148:151]
    ds_read_b128 v[88:91], v164 offset:2112
    s_waitcnt lgkmcnt(7)
    v_mfma_f32_16x16x32_bf16 v[152:155], v[60:63], v[72:75], v[152:155]
    ds_read_b64 v[100:101], v163 offset:2112
    ds_read_b64 v[102:103], v163 offset:2120
    s_waitcnt lgkmcnt(8)
    v_mfma_f32_16x16x32_bf16 v[148:151], v[60:63], v[68:71], v[148:151]
    ds_read_b128 v[80:83], v164 offset:1600
    s_waitcnt lgkmcnt(7)
    v_mfma_f32_16x16x32_bf16 v[152:155], v[56:59], v[68:71], v[152:155]
    ds_read_b64 v[96:97], v163 offset:1600
    ds_read_b64 v[98:99], v163 offset:1608
    s_waitcnt lgkmcnt(6)
    v_mfma_f32_16x16x32_bf16 v[152:155], v[64:67], v[84:87], v[152:155]
    ds_read_b128 v[76:79], v164 offset:1088
    s_waitcnt lgkmcnt(6)
    v_mfma_f32_16x16x32_bf16 v[148:151], v[64:67], v[88:91], v[148:151]
    ds_read_b64 v[92:93], v163 offset:1088
    ds_read_b64 v[94:95], v163 offset:1096
    s_waitcnt lgkmcnt(6)
    v_mfma_f32_16x16x32_bf16 v[152:155], v[100:103], v[88:91], v[152:155]
    ds_read_b128 v[112:115], v164 offset:576
    s_waitcnt lgkmcnt(6)
    v_mfma_f32_16x16x32_bf16 v[148:151], v[100:103], v[80:83], v[148:151]
    ds_read_b64 v[104:105], v163 offset:576
    ds_read_b64 v[106:107], v163 offset:584
    s_waitcnt lgkmcnt(6)
    v_mfma_f32_16x16x32_bf16 v[152:155], v[96:99], v[80:83], v[152:155]
    ds_read_b128 v[124:127], v164 offset:64
    s_waitcnt lgkmcnt(6)
    v_mfma_f32_16x16x32_bf16 v[148:151], v[96:99], v[76:79], v[148:151]
    ds_read_b64 v[116:117], v163 offset:64
    ds_read_b64 v[118:119], v163 offset:72
    s_waitcnt lgkmcnt(6)
    v_mfma_f32_16x16x32_bf16 v[152:155], v[92:95], v[76:79], v[152:155]
    ds_read_b64 v[128:129], v163 offset:2560
    ds_read_b64 v[130:131], v163 offset:2568
    ds_read_b128 v[108:111], v164 offset:2560
    s_waitcnt lgkmcnt(8)
    v_mfma_f32_16x16x32_bf16 v[148:151], v[92:95], v[112:115], v[148:151]
    ds_read_b128 v[120:123], v164 offset:2048
    s_waitcnt lgkmcnt(7)
    v_mfma_f32_16x16x32_bf16 v[152:155], v[104:107], v[112:115], v[152:155]
    ds_read_b64 v[132:133], v163 offset:2048
    ds_read_b64 v[134:135], v163 offset:2056
    s_waitcnt lgkmcnt(8)
    v_mfma_f32_16x16x32_bf16 v[148:151], v[104:107], v[124:127], v[148:151]
    ds_read_b128 v[44:47], v164 offset:1536
    s_waitcnt lgkmcnt(7)
    v_mfma_f32_16x16x32_bf16 v[152:155], v[116:119], v[124:127], v[152:155]
    ds_read_b64 v[136:137], v163 offset:1536
    ds_read_b64 v[138:139], v163 offset:1544
    s_waitcnt lgkmcnt(6)
    v_mfma_f32_16x16x32_bf16 v[152:155], v[128:131], v[108:111], v[152:155]
    ds_read_b128 v[24:27], v164 offset:1024
    s_waitcnt lgkmcnt(6)
    v_mfma_f32_16x16x32_bf16 v[148:151], v[128:131], v[120:123], v[148:151]
    ds_read_b64 v[28:29], v163 offset:1024
    ds_read_b64 v[30:31], v163 offset:1032
    s_waitcnt lgkmcnt(6)
    v_mfma_f32_16x16x32_bf16 v[152:155], v[132:135], v[120:123], v[152:155]
    ds_read_b128 v[32:35], v164 offset:512
    s_waitcnt lgkmcnt(6)
    v_mfma_f32_16x16x32_bf16 v[148:151], v[132:135], v[44:47], v[148:151]
    ds_read_b64 v[52:53], v163 offset:512
    ds_read_b64 v[54:55], v163 offset:520
    s_waitcnt lgkmcnt(6)
    v_mfma_f32_16x16x32_bf16 v[152:155], v[136:139], v[44:47], v[152:155]
    ds_read_b128 v[36:39], v164 offset:0
    s_waitcnt lgkmcnt(6)
    v_mfma_f32_16x16x32_bf16 v[148:151], v[136:139], v[24:27], v[148:151]
    ds_read_b64 v[48:49], v163 offset:0
    ds_read_b64 v[50:51], v163 offset:8
    s_waitcnt lgkmcnt(6)
    v_mfma_f32_16x16x32_bf16 v[152:155], v[28:31], v[24:27], v[152:155]
    s_waitcnt lgkmcnt(5)
    v_mfma_f32_16x16x32_bf16 v[148:151], v[28:31], v[32:35], v[148:151]
    s_waitcnt lgkmcnt(3)
    v_mfma_f32_16x16x32_bf16 v[152:155], v[52:55], v[32:35], v[152:155]
    s_waitcnt lgkmcnt(2)
    v_mfma_f32_16x16x32_bf16 v[148:151], v[52:55], v[36:39], v[148:151]
    s_waitcnt lgkmcnt(0)
    v_mfma_f32_16x16x32_bf16 v[152:155], v[48:51], v[36:39], v[152:155]
    s_nop 7
    v_cvt_pk_bf16_f32 v8, v148, v149
    v_cvt_pk_bf16_f32 v9, v150, v151
    v_cvt_pk_bf16_f32 v10, v152, v153
    v_cvt_pk_bf16_f32 v11, v154, v155
    ds_write_b64 v165, v[8:9] offset:1024
    ds_write_b64 v165, v[10:11] offset:1536
    s_waitcnt lgkmcnt(0)
    s_barrier
    s_branch L_fin
L_type2:
    ds_read_b128 v[24:27], v164 offset:3008
    ds_read_b128 v[28:31], v164 offset:2496
    ds_read_b128 v[32:35], v164 offset:1984
    ds_read_b128 v[36:39], v164 offset:1472
    ds_read_b128 v[40:43], v164 offset:2944
    s_barrier
    s_setprio 2
    ds_read_b128 v[4:7], v166
    ds_read_b64 v[44:45], v163 offset:4032
    ds_read_b64 v[46:47], v163 offset:4040
    ds_read_b64 v[48:49], v163 offset:3520
    ds_read_b64 v[50:51], v163 offset:3528
    ds_read_b64 v[52:53], v163 offset:3008
    ds_read_b64 v[54:55], v163 offset:3016
    ds_read_b64 v[56:57], v163 offset:2496
    ds_read_b64 v[58:59], v163 offset:2504
    s_waitcnt lgkmcnt(8)
    v_pk_add_f32 v[124:125], v[124:125], v[4:5]
    v_pk_add_f32 v[126:127], v[126:127], v[6:7]
    v_add_f32 v124, v124, v167
    v_cvt_pk_bf16_f32 v5, v126, v127
    v_cvt_pk_bf16_f32 v4, v124, v125
    ds_write_b64 v162, v[4:5]
    s_waitcnt lgkmcnt(7)
    v_mfma_f32_16x16x32_bf16 v[152:155], v[44:47], v[24:27], v[152:155]
    v_mfma_f32_16x16x32_bf16 v[148:151], v[44:47], v[28:31], v[148:151]
    v_mfma_f32_16x16x32_bf16 v[144:147], v[44:47], v[32:35], v[144:147]
    v_mfma_f32_16x16x32_bf16 v[140:143], v[44:47], v[36:39], v[140:143]
    s_waitcnt lgkmcnt(5)
    v_mfma_f32_16x16x32_bf16 v[152:155], v[48:51], v[28:31], v[152:155]
    v_mfma_f32_16x16x32_bf16 v[148:151], v[48:51], v[32:35], v[148:151]
    ds_read_b128 v[60:63], v164 offset:960
    v_mfma_f32_16x16x32_bf16 v[144:147], v[48:51], v[36:39], v[144:147]
    s_waitcnt lgkmcnt(4)
    v_mfma_f32_16x16x32_bf16 v[152:155], v[52:55], v[32:35], v[152:155]
    ds_read_b128 v[64:67], v164 offset:448
    v_mfma_f32_16x16x32_bf16 v[148:151], v[52:55], v[36:39], v[148:151]
    s_waitcnt lgkmcnt(3)
    v_mfma_f32_16x16x32_bf16 v[152:155], v[56:59], v[36:39], v[152:155]
    s_waitcnt lgkmcnt(1)
    v_mfma_f32_16x16x32_bf16 v[140:143], v[48:51], v[60:63], v[140:143]
    ds_read_b64 v[68:69], v163 offset:3968
    ds_read_b64 v[70:71], v163 offset:3976
    v_mfma_f32_16x16x32_bf16 v[144:147], v[52:55], v[60:63], v[144:147]
    ds_read_b128 v[72:75], v164 offset:2432
    s_waitcnt lgkmcnt(3)
    v_mfma_f32_16x16x32_bf16 v[140:143], v[52:55], v[64:67], v[140:143]
    ds_read_b128 v[76:79], v164 offset:1920
    v_mfma_f32_16x16x32_bf16 v[148:151], v[56:59], v[60:63], v[148:151]
    ds_read_b128 v[80:83], v164 offset:1408
    v_mfma_f32_16x16x32_bf16 v[144:147], v[56:59], v[64:67], v[144:147]
    ds_read_b64 v[84:85], v163 offset:3456
    ds_read_b64 v[86:87], v163 offset:3464
    s_waitcnt lgkmcnt(5)
    v_mfma_f32_16x16x32_bf16 v[152:155], v[68:71], v[40:43], v[152:155]
    s_waitcnt lgkmcnt(4)
    v_mfma_f32_16x16x32_bf16 v[148:151], v[68:71], v[72:75], v[148:151]
    s_waitcnt lgkmcnt(3)
    v_mfma_f32_16x16x32_bf16 v[144:147], v[68:71], v[76:79], v[144:147]
    ds_read_b64 v[88:89], v163 offset:2944
    ds_read_b64 v[90:91], v163 offset:2952
    s_waitcnt lgkmcnt(4)
    v_mfma_f32_16x16x32_bf16 v[140:143], v[68:71], v[80:83], v[140:143]
    s_waitcnt lgkmcnt(2)
    v_mfma_f32_16x16x32_bf16 v[152:155], v[84:87], v[72:75], v[152:155]
    ds_read_b64 v[92:93], v163 offset:2432
    ds_read_b64 v[94:95], v163 offset:2440
    v_mfma_f32_16x16x32_bf16 v[148:151], v[84:87], v[76:79], v[148:151]
    ds_read_b128 v[96:99], v164 offset:896
    v_mfma_f32_16x16x32_bf16 v[144:147], v[84:87], v[80:83], v[144:147]
    s_waitcnt lgkmcnt(3)
    v_mfma_f32_16x16x32_bf16 v[152:155], v[88:91], v[76:79], v[152:155]
    ds_read_b128 v[100:103], v164 offset:384
    v_mfma_f32_16x16x32_bf16 v[148:151], v[88:91], v[80:83], v[148:151]
    s_waitcnt lgkmcnt(2)
    v_mfma_f32_16x16x32_bf16 v[152:155], v[92:95], v[80:83], v[152:155]
    s_waitcnt lgkmcnt(1)
    v_mfma_f32_16x16x32_bf16 v[140:143], v[84:87], v[96:99], v[140:143]
    ds_read_b64 v[104:105], v163 offset:3904
    ds_read_b64 v[106:107], v163 offset:3912
    ds_read_b128 v[108:111], v164 offset:2880
    v_mfma_f32_16x16x32_bf16 v[144:147], v[88:91], v[96:99], v[144:147]
    ds_read_b128 v[112:115], v164 offset:2368
    s_waitcnt lgkmcnt(4)
    v_mfma_f32_16x16x32_bf16 v[140:143], v[88:91], v[100:103], v[140:143]
    ds_read_b128 v[116:119], v164 offset:1856
    v_mfma_f32_16x16x32_bf16 v[148:151], v[92:95], v[96:99], v[148:151]
    ds_read_b128 v[120:123], v164 offset:1344
    v_mfma_f32_16x16x32_bf16 v[144:147], v[92:95], v[100:103], v[144:147]
    ds_read_b64 v[124:125], v163 offset:3392
    ds_read_b64 v[126:127], v163 offset:3400
    s_waitcnt lgkmcnt(5)
    v_mfma_f32_16x16x32_bf16 v[152:155], v[104:107], v[108:111], v[152:155]
    s_waitcnt lgkmcnt(4)
    v_mfma_f32_16x16x32_bf16 v[148:151], v[104:107], v[112:115], v[148:151]
    s_waitcnt lgkmcnt(3)
    v_mfma_f32_16x16x32_bf16 v[144:147], v[104:107], v[116:119], v[144:147]
    ds_read_b64 v[128:129], v163 offset:2880
    ds_read_b64 v[130:131], v163 offset:2888
    s_waitcnt lgkmcnt(4)
    v_mfma_f32_16x16x32_bf16 v[140:143], v[104:107], v[120:123], v[140:143]
    s_waitcnt lgkmcnt(2)
    v_mfma_f32_16x16x32_bf16 v[152:155], v[124:127], v[112:115], v[152:155]
    ds_read_b64 v[132:133], v163 offset:2368
    ds_read_b64 v[134:135], v163 offset:2376
    v_mfma_f32_16x16x32_bf16 v[148:151], v[124:127], v[116:119], v[148:151]
    ds_read_b128 v[136:139], v164 offset:832
    v_mfma_f32_16x16x32_bf16 v[144:147], v[124:127], v[120:123], v[144:147]
    s_waitcnt lgkmcnt(3)
    v_mfma_f32_16x16x32_bf16 v[152:155], v[128:131], v[116:119], v[152:155]
    ds_read_b128 v[24:27], v164 offset:320
    v_mfma_f32_16x16x32_bf16 v[148:151], v[128:131], v[120:123], v[148:151]
    s_waitcnt lgkmcnt(2)
    v_mfma_f32_16x16x32_bf16 v[152:155], v[132:135], v[120:123], v[152:155]
    s_waitcnt lgkmcnt(1)
    v_mfma_f32_16x16x32_bf16 v[140:143], v[124:127], v[136:139], v[140:143]
    ds_read_b64 v[28:29], v163 offset:3840
    ds_read_b64 v[30:31], v163 offset:3848
    ds_read_b128 v[44:47], v164 offset:2816
    v_mfma_f32_16x16x32_bf16 v[144:147], v[128:131], v[136:139], v[144:147]
    ds_read_b128 v[32:35], v164 offset:2304
    s_waitcnt lgkmcnt(4)
    v_mfma_f32_16x16x32_bf16 v[140:143], v[128:131], v[24:27], v[140:143]
    ds_read_b128 v[36:39], v164 offset:1792
    v_mfma_f32_16x16x32_bf16 v[148:151], v[132:135], v[136:139], v[148:151]
    ds_read_b128 v[48:51], v164 offset:1280
    v_mfma_f32_16x16x32_bf16 v[144:147], v[132:135], v[24:27], v[144:147]
    ds_read_b64 v[52:53], v163 offset:3328
    ds_read_b64 v[54:55], v163 offset:3336
    s_waitcnt lgkmcnt(5)
    v_mfma_f32_16x16x32_bf16 v[152:155], v[28:31], v[44:47], v[152:155]
    s_waitcnt lgkmcnt(4)
    v_mfma_f32_16x16x32_bf16 v[148:151], v[28:31], v[32:35], v[148:151]
    s_waitcnt lgkmcnt(3)
    v_mfma_f32_16x16x32_bf16 v[144:147], v[28:31], v[36:39], v[144:147]
    ds_read_b64 v[60:61], v163 offset:2816
    ds_read_b64 v[62:63], v163 offset:2824
    s_waitcnt lgkmcnt(4)
    v_mfma_f32_16x16x32_bf16 v[140:143], v[28:31], v[48:51], v[140:143]
    s_waitcnt lgkmcnt(2)
    v_mfma_f32_16x16x32_bf16 v[152:155], v[52:55], v[32:35], v[152:155]
    ds_read_b64 v[56:57], v163 offset:2304
    ds_read_b64 v[58:59], v163 offset:2312
    v_mfma_f32_16x16x32_bf16 v[148:151], v[52:55], v[36:39], v[148:151]
    ds_read_b128 v[64:67], v164 offset:768
    v_mfma_f32_16x16x32_bf16 v[144:147], v[52:55], v[48:51], v[144:147]
    s_waitcnt lgkmcnt(3)
    v_mfma_f32_16x16x32_bf16 v[152:155], v[60:63], v[36:39], v[152:155]
    ds_read_b128 v[40:43], v164 offset:256
    v_mfma_f32_16x16x32_bf16 v[148:151], v[60:63], v[48:51], v[148:151]
    s_waitcnt lgkmcnt(2)
    v_mfma_f32_16x16x32_bf16 v[152:155], v[56:59], v[48:51], v[152:155]
    s_waitcnt lgkmcnt(1)
    v_mfma_f32_16x16x32_bf16 v[140:143], v[52:55], v[64:67], v[140:143]
    ds_read_b64 v[68:69], v163 offset:3776
    ds_read_b64 v[70:71], v163 offset:3784
    ds_read_b128 v[72:75], v164 offset:2752
    v_mfma_f32_16x16x32_bf16 v[144:147], v[60:63], v[64:67], v[144:147]
    ds_read_b128 v[76:79], v164 offset:2240
    s_waitcnt lgkmcnt(4)
    v_mfma_f32_16x16x32_bf16 v[140:143], v[60:63], v[40:43], v[140:143]
    ds_read_b128 v[80:83], v164 offset:1728
    v_mfma_f32_16x16x32_bf16 v[148:151], v[56:59], v[64:67], v[148:151]
    ds_read_b128 v[84:87], v164 offset:1216
    v_mfma_f32_16x16x32_bf16 v[144:147], v[56:59], v[40:43], v[144:147]
    ds_read_b64 v[88:89], v163 offset:3264
    ds_read_b64 v[90:91], v163 offset:3272
    s_waitcnt lgkmcnt(5)
    v_mfma_f32_16x16x32_bf16 v[152:155], v[68:71], v[72:75], v[152:155]
    s_waitcnt lgkmcnt(4)
    v_mfma_f32_16x16x32_bf16 v[148:151], v[68:71], v[76:79], v[148:151]
    s_waitcnt lgkmcnt(3)
    v_mfma_f32_16x16x32_bf16 v[144:147], v[68:71], v[80:83], v[144:147]
    ds_read_b64 v[96:97], v163 offset:2752
    ds_read_b64 v[98:99], v163 offset:2760
    s_waitcnt lgkmcnt(4)
    v_mfma_f32_16x16x32_bf16 v[140:143], v[68:71], v[84:87], v[140:143]
    s_waitcnt lgkmcnt(2)
    v_mfma_f32_16x16x32_bf16 v[152:155], v[88:91], v[76:79], v[152:155]
    ds_read_b64 v[92:93], v163 offset:2240
    ds_read_b64 v[94:95], v163 offset:2248
    v_mfma_f32_16x16x32_bf16 v[148:151], v[88:91], v[80:83], v[148:151]
    ds_read_b128 v[100:103], v164 offset:704
    v_mfma_f32_16x16x32_bf16 v[144:147], v[88:91], v[84:87], v[144:147]
    s_waitcnt lgkmcnt(3)
    v_mfma_f32_16x16x32_bf16 v[152:155], v[96:99], v[80:83], v[152:155]
    ds_read_b128 v[108:111], v164 offset:192
    v_mfma_f32_16x16x32_bf16 v[148:151], v[96:99], v[84:87], v[148:151]
    s_waitcnt lgkmcnt(2)
    v_mfma_f32_16x16x32_bf16 v[152:155], v[92:95], v[84:87], v[152:155]
    s_waitcnt lgkmcnt(1)
    v_mfma_f32_16x16x32_bf16 v[140:143], v[88:91], v[100:103], v[140:143]
    ds_read_b64 v[104:105], v163 offset:3712
    ds_read_b64 v[106:107], v163 offset:3720
    ds_read_b128 v[112:115], v164 offset:2688
    v_mfma_f32_16x16x32_bf16 v[144:147], v[96:99], v[100:103], v[144:147]
    ds_read_b128 v[116:119], v164 offset:2176
    s_waitcnt lgkmcnt(4)
    v_mfma_f32_16x16x32_bf16 v[140:143], v[96:99], v[108:111], v[140:143]
    ds_read_b128 v[120:123], v164 offset:1664
    v_mfma_f32_16x16x32_bf16 v[148:151], v[92:95], v[100:103], v[148:151]
    ds_read_b128 v[124:127], v164 offset:1152
    v_mfma_f32_16x16x32_bf16 v[144:147], v[92:95], v[108:111], v[144:147]
    ds_read_b64 v[128:129], v163 offset:3200
    ds_read_b64 v[130:131], v163 offset:3208
    s_waitcnt lgkmcnt(5)
    v_mfma_f32_16x16x32_bf16 v[152:155], v[104:107], v[112:115], v[152:155]
    s_waitcnt lgkmcnt(4)
    v_mfma_f32_16x16x32_bf16 v[148:151], v[104:107], v[116:119], v[148:151]
    s_waitcnt lgkmcnt(3)
    v_mfma_f32_16x16x32_bf16 v[144:147], v[104:107], v[120:123], v[144:147]
    ds_read_b64 v[136:137], v163 offset:2688
    ds_read_b64 v[138:139], v163 offset:2696
    s_waitcnt lgkmcnt(4)
    v_mfma_f32_16x16x32_bf16 v[140:143], v[104:107], v[124:127], v[140:143]
    s_waitcnt lgkmcnt(2)
    v_mfma_f32_16x16x32_bf16 v[152:155], v[128:131], v[116:119], v[152:155]
    ds_read_b64 v[132:133], v163 offset:2176
    ds_read_b64 v[134:135], v163 offset:2184
    v_mfma_f32_16x16x32_bf16 v[148:151], v[128:131], v[120:123], v[148:151]
    ds_read_b128 v[24:27], v164 offset:640
    v_mfma_f32_16x16x32_bf16 v[144:147], v[128:131], v[124:127], v[144:147]
    s_waitcnt lgkmcnt(3)
    v_mfma_f32_16x16x32_bf16 v[152:155], v[136:139], v[120:123], v[152:155]
    ds_read_b128 v[44:47], v164 offset:128
    v_mfma_f32_16x16x32_bf16 v[148:151], v[136:139], v[124:127], v[148:151]
    s_waitcnt lgkmcnt(2)
    v_mfma_f32_16x16x32_bf16 v[152:155], v[132:135], v[124:127], v[152:155]
    s_waitcnt lgkmcnt(1)
    v_mfma_f32_16x16x32_bf16 v[140:143], v[128:131], v[24:27], v[140:143]
    ds_read_b64 v[28:29], v163 offset:3648
    ds_read_b64 v[30:31], v163 offset:3656
    ds_read_b128 v[32:35], v164 offset:2624
    v_mfma_f32_16x16x32_bf16 v[144:147], v[136:139], v[24:27], v[144:147]
    ds_read_b128 v[36:39], v164 offset:2112
    s_waitcnt lgkmcnt(4)
    v_mfma_f32_16x16x32_bf16 v[140:143], v[136:139], v[44:47], v[140:143]
    ds_read_b128 v[48:51], v164 offset:1600
    v_mfma_f32_16x16x32_bf16 v[148:151], v[132:135], v[24:27], v[148:151]
    ds_read_b128 v[52:55], v164 offset:1088
    v_mfma_f32_16x16x32_bf16 v[144:147], v[132:135], v[44:47], v[144:147]
    ds_read_b64 v[60:61], v163 offset:3136
    ds_read_b64 v[62:63], v163 offset:3144
    s_waitcnt lgkmcnt(5)
    v_mfma_f32_16x16x32_bf16 v[152:155], v[28:31], v[32:35], v[152:155]
    s_waitcnt lgkmcnt(4)
    v_mfma_f32_16x16x32_bf16 v[148:151], v[28:31], v[36:39], v[148:151]
    s_waitcnt lgkmcnt(3)
    v_mfma_f32_16x16x32_bf16 v[144:147], v[28:31], v[48:51], v[144:147]
    ds_read_b64 v[64:65], v163 offset:2624
    ds_read_b64 v[66:67], v163 offset:2632
    s_waitcnt lgkmcnt(4)
    v_mfma_f32_16x16x32_bf16 v[140:143], v[28:31], v[52:55], v[140:143]
    s_waitcnt lgkmcnt(2)
    v_mfma_f32_16x16x32_bf16 v[152:155], v[60:63], v[36:39], v[152:155]
    ds_read_b64 v[56:57], v163 offset:2112
    ds_read_b64 v[58:59], v163 offset:2120
    v_mfma_f32_16x16x32_bf16 v[148:151], v[60:63], v[48:51], v[148:151]
    ds_read_b128 v[40:43], v164 offset:576
    v_mfma_f32_16x16x32_bf16 v[144:147], v[60:63], v[52:55], v[144:147]
    s_waitcnt lgkmcnt(3)
    v_mfma_f32_16x16x32_bf16 v[152:155], v[64:67], v[48:51], v[152:155]
    ds_read_b128 v[72:75], v164 offset:64
    v_mfma_f32_16x16x32_bf16 v[148:151], v[64:67], v[52:55], v[148:151]
    s_waitcnt lgkmcnt(2)
    v_mfma_f32_16x16x32_bf16 v[152:155], v[56:59], v[52:55], v[152:155]
    s_waitcnt lgkmcnt(1)
    v_mfma_f32_16x16x32_bf16 v[140:143], v[60:63], v[40:43], v[140:143]
    ds_read_b64 v[68:69], v163 offset:3584
    ds_read_b64 v[70:71], v163 offset:3592
    ds_read_b128 v[76:79], v164 offset:2560
    v_mfma_f32_16x16x32_bf16 v[144:147], v[64:67], v[40:43], v[144:147]
    ds_read_b128 v[80:83], v164 offset:2048
    s_waitcnt lgkmcnt(4)
    v_mfma_f32_16x16x32_bf16 v[140:143], v[64:67], v[72:75], v[140:143]
    ds_read_b128 v[84:87], v164 offset:1536
    v_mfma_f32_16x16x32_bf16 v[148:151], v[56:59], v[40:43], v[148:151]
    ds_read_b128 v[88:91], v164 offset:1024
    v_mfma_f32_16x16x32_bf16 v[144:147], v[56:59], v[72:75], v[144:147]
    ds_read_b64 v[96:97], v163 offset:3072
    ds_read_b64 v[98:99], v163 offset:3080
    s_waitcnt lgkmcnt(5)
    v_mfma_f32_16x16x32_bf16 v[152:155], v[68:71], v[76:79], v[152:155]
    s_waitcnt lgkmcnt(4)
    v_mfma_f32_16x16x32_bf16 v[148:151], v[68:71], v[80:83], v[148:151]
    s_waitcnt lgkmcnt(3)
    v_mfma_f32_16x16x32_bf16 v[144:147], v[68:71], v[84:87], v[144:147]
    ds_read_b64 v[100:101], v163 offset:2560
    ds_read_b64 v[102:103], v163 offset:2568
    s_waitcnt lgkmcnt(4)
    v_mfma_f32_16x16x32_bf16 v[140:143], v[68:71], v[88:91], v[140:143]
    s_waitcnt lgkmcnt(2)
    v_mfma_f32_16x16x32_bf16 v[152:155], v[96:99], v[80:83], v[152:155]
    ds_read_b64 v[92:93], v163 offset:2048
    ds_read_b64 v[94:95], v163 offset:2056
    v_mfma_f32_16x16x32_bf16 v[148:151], v[96:99], v[84:87], v[148:151]
    ds_read_b128 v[108:111], v164 offset:512
    v_mfma_f32_16x16x32_bf16 v[144:147], v[96:99], v[88:91], v[144:147]
    s_waitcnt lgkmcnt(3)
    v_mfma_f32_16x16x32_bf16 v[152:155], v[100:103], v[84:87], v[152:155]
    ds_read_b128 v[112:115], v164 offset:0
    v_mfma_f32_16x16x32_bf16 v[148:151], v[100:103], v[88:91], v[148:151]
    s_waitcnt lgkmcnt(2)
    v_mfma_f32_16x16x32_bf16 v[152:155], v[92:95], v[88:91], v[152:155]
    s_waitcnt lgkmcnt(1)
    v_mfma_f32_16x16x32_bf16 v[140:143], v[96:99], v[108:111], v[140:143]
    v_mfma_f32_16x16x32_bf16 v[144:147], v[100:103], v[108:111], v[144:147]
    s_waitcnt lgkmcnt(0)
    v_mfma_f32_16x16x32_bf16 v[140:143], v[100:103], v[112:115], v[140:143]
    v_mfma_f32_16x16x32_bf16 v[148:151], v[92:95], v[108:111], v[148:151]
    v_mfma_f32_16x16x32_bf16 v[144:147], v[92:95], v[112:115], v[144:147]
    ds_read_b128 v[104:107], v164 offset:960
    ds_read_b128 v[116:119], v164 offset:448
    s_nop 5
    v_cvt_pk_bf16_f32 v8, v140, v141
    v_cvt_pk_bf16_f32 v9, v142, v143
    v_cvt_pk_bf16_f32 v10, v144, v145
    v_cvt_pk_bf16_f32 v11, v146, v147
    ds_write_b64 v165, v[8:9] offset:0
    ds_write_b64 v165, v[10:11] offset:512
    s_waitcnt lgkmcnt(0)
    s_barrier
    ds_read_b64 v[120:121], v163 offset:1984
    ds_read_b64 v[122:123], v163 offset:1992
    ds_read_b64 v[124:125], v163 offset:1472
    ds_read_b64 v[126:127], v163 offset:1480
    ds_read_b64 v[128:129], v163 offset:1920
    ds_read_b64 v[130:131], v163 offset:1928
    ds_read_b128 v[136:139], v164 offset:896
    ds_read_b128 v[24:27], v164 offset:384
    s_waitcnt lgkmcnt(6)
    v_mfma_f32_16x16x32_bf16 v[152:155], v[120:123], v[104:107], v[152:155]
    ds_read_b64 v[132:133], v163 offset:1408
    ds_read_b64 v[134:135], v163 offset:1416
    v_mfma_f32_16x16x32_bf16 v[148:151], v[120:123], v[116:119], v[148:151]
    ds_read_b64 v[44:45], v163 offset:1856
    ds_read_b64 v[46:47], v163 offset:1864
    ds_read_b128 v[32:35], v164 offset:832
    s_waitcnt lgkmcnt(9)
    v_mfma_f32_16x16x32_bf16 v[152:155], v[124:127], v[116:119], v[152:155]
    ds_read_b128 v[28:31], v164 offset:320
    s_waitcnt lgkmcnt(7)
    v_mfma_f32_16x16x32_bf16 v[152:155], v[128:131], v[136:139], v[152:155]
    ds_read_b64 v[36:37], v163 offset:1344
    ds_read_b64 v[38:39], v163 offset:1352
    s_waitcnt lgkmcnt(8)
    v_mfma_f32_16x16x32_bf16 v[148:151], v[128:131], v[24:27], v[148:151]
    ds_read_b64 v[48:49], v163 offset:1792
    ds_read_b64 v[50:51], v163 offset:1800
    ds_read_b128 v[52:55], v164 offset:768
    s_waitcnt lgkmcnt(9)
    v_mfma_f32_16x16x32_bf16 v[152:155], v[132:135], v[24:27], v[152:155]
    ds_read_b128 v[60:63], v164 offset:256
    s_waitcnt lgkmcnt(7)
    v_mfma_f32_16x16x32_bf16 v[152:155], v[44:47], v[32:35], v[152:155]
    ds_read_b64 v[64:65], v163 offset:1280
    ds_read_b64 v[66:67], v163 offset:1288
    s_waitcnt lgkmcnt(8)
    v_mfma_f32_16x16x32_bf16 v[148:151], v[44:47], v[28:31], v[148:151]
    ds_read_b64 v[40:41], v163 offset:1728
    ds_read_b64 v[42:43], v163 offset:1736
    ds_read_b128 v[56:59], v164 offset:704
    s_waitcnt lgkmcnt(9)
    v_mfma_f32_16x16x32_bf16 v[152:155], v[36:39], v[28:31], v[152:155]
    ds_read_b128 v[72:75], v164 offset:192
    s_waitcnt lgkmcnt(7)
    v_mfma_f32_16x16x32_bf16 v[152:155], v[48:51], v[52:55], v[152:155]
    ds_read_b64 v[76:77], v163 offset:1216
    ds_read_b64 v[78:79], v163 offset:1224
    s_waitcnt lgkmcnt(8)
    v_mfma_f32_16x16x32_bf16 v[148:151], v[48:51], v[60:63], v[148:151]
    ds_read_b64 v[68:69], v163 offset:1664
    ds_read_b64 v[70:71], v163 offset:1672
    ds_read_b128 v[80:83], v164 offset:640
    s_waitcnt lgkmcnt(9)
    v_mfma_f32_16x16x32_bf16 v[152:155], v[64:67], v[60:63], v[152:155]
    ds_read_b128 v[84:87], v164 offset:128
    s_waitcnt lgkmcnt(7)
    v_mfma_f32_16x16x32_bf16 v[152:155], v[40:43], v[56:59], v[152:155]
    ds_read_b64 v[88:89], v163 offset:1152
    ds_read_b64 v[90:91], v163 offset:1160
    s_waitcnt lgkmcnt(8)
    v_mfma_f32_16x16x32_bf16 v[148:151], v[40:43], v[72:75], v[148:151]
    ds_read_b64 v[96:97], v163 offset:1600
    ds_read_b64 v[98:99], v163 offset:1608
    ds_read_b128 v[100:103], v164 offset:576
    s_waitcnt lgkmcnt(9)
    v_mfma_f32_16x16x32_bf16 v[152:155], v[76:79], v[72:75], v[152:155]
    ds_read_b128 v[92:95], v164 offset:64
    s_waitcnt lgkmcnt(7)
    v_mfma_f32_16x16x32_bf16 v[152:155], v[68:71], v[80:83], v[152:155]
    ds_read_b64 v[108:109], v163 offset:1088
    ds_read_b64 v[110:111], v163 offset:1096
    s_waitcnt lgkmcnt(8)
    v_mfma_f32_16x16x32_bf16 v[148:151], v[68:71], v[84:87], v[148:151]
    ds_read_b64 v[112:113], v163 offset:1536
    ds_read_b64 v[114:115], v163 offset:1544
    ds_read_b128 v[104:107], v164 offset:512
    s_waitcnt lgkmcnt(9)
    v_mfma_f32_16x16x32_bf16 v[152:155], v[88:91], v[84:87], v[152:155]
    ds_read_b128 v[120:123], v164 offset:0
    s_waitcnt lgkmcnt(7)
    v_mfma_f32_16x16x32_bf16 v[152:155], v[96:99], v[100:103], v[152:155]
    ds_read_b64 v[116:117], v163 offset:1024
    ds_read_b64 v[118:119], v163 offset:1032
    s_waitcnt lgkmcnt(8)
    v_mfma_f32_16x16x32_bf16 v[148:151], v[96:99], v[92:95], v[148:151]
    s_waitcnt lgkmcnt(6)
    v_mfma_f32_16x16x32_bf16 v[152:155], v[108:111], v[92:95], v[152:155]
    s_waitcnt lgkmcnt(3)
    v_mfma_f32_16x16x32_bf16 v[152:155], v[112:115], v[104:107], v[152:155]
    s_waitcnt lgkmcnt(2)
    v_mfma_f32_16x16x32_bf16 v[148:151], v[112:115], v[120:123], v[148:151]
    s_waitcnt lgkmcnt(0)
    v_mfma_f32_16x16x32_bf16 v[152:155], v[116:119], v[120:123], v[152:155]
    s_nop 7
    v_cvt_pk_bf16_f32 v8, v148, v149
    v_cvt_pk_bf16_f32 v9, v150, v151
    v_cvt_pk_bf16_f32 v10, v152, v153
    v_cvt_pk_bf16_f32 v11, v154, v155
    ds_write_b64 v165, v[8:9] offset:1024
    ds_write_b64 v165, v[10:11] offset:1536
    s_waitcnt lgkmcnt(0)
    s_barrier
    s_branch L_fin
L_uwave:
    s_setprio 3
    s_sub_u32 s9, s4, 8
    v_subrev_u32 v5, 512, v0
    v_lshrrev_b32 v6, 3, v5
    v_lshlrev_b32 v6, 10, v6
    v_and_b32 v7, 7, v5
    v_lshlrev_b32 v7, 4, v7
    s_lshl_b32 s10, s6, 16
    s_lshl_b32 s11, s5, 7
    s_add_u32 s10, s10, s11
    v_add3_u32 v6, v6, v7, s10
    v_add_u32 v7, 0x8000, v6
    s_waitcnt lgkmcnt(0)
    global_load_dwordx4 v[44:47], v6, s[16:17]
    global_load_dwordx4 v[48:51], v7, s[16:17]
    v_lshlrev_b32 v2, 12, v1
    s_lshl_b32 s10, s9, 18
    s_lshl_b32 s11, s8, 1
    s_add_u32 s10, s10, s11
    v_add_u32 v2, s10, v2
    v_lshrrev_b32 v5, 1, v1
    v_mul_u32_u24 v5, 4160, v5
    v_and_b32 v6, 1, v1
    v_lshlrev_b32 v6, 4, v6
    s_mul_i32 s11, s9, 16640
    s_add_u32 s11, s11, 59392
    v_add3_u32 v5, v5, v6, s11
    v_mov_b32 v52, 0
    v_mov_b32 v53, 0
    v_mov_b32 v54, 0
    v_mov_b32 v55, 0
    s_mov_b64 exec, 0xff
    ds_write_b128 v5, v[52:55]
    s_mov_b64 exec, -1
    s_mov_b32 s44, 0x05040100
    s_mov_b32 s45, 0x07060302
    v_lshlrev_b32 v5, 3, v1
    s_lshl_b32 s11, s9, 9
    s_sub_u32 s11, 59384, s11
    v_sub_u32 v93, s11, v5
    v_subrev_u32 v4, 3072, v2
    v_max_i32 v4, v4, 0
    s_lshr_b32 s10, s9, 1
    s_and_b32 s10, s10, s7
    s_barrier
    s_waitcnt vmcnt(0)
    s_mov_b64 exec, 1
    global_load_dwordx2 v[28:29], v4, s[16:17] offset:0
    global_load_dwordx2 v[30:31], v4, s[16:17] offset:1024
    global_load_dwordx2 v[32:33], v4, s[16:17] offset:2048
    s_mov_b64 exec, -1
    global_load_dwordx2 v[8:9], v2, s[16:17] offset:0
    global_load_dwordx2 v[10:11], v2, s[16:17] offset:1024
    global_load_dwordx2 v[12:13], v2, s[16:17] offset:2048
    global_load_dwordx2 v[14:15], v2, s[16:17] offset:3072
L_b0j:
    s_setprio 3
    s_waitcnt vmcnt(0)
    s_cmp_lg_u32 s9, 0
    s_cbranch_scc1 L_nz
    v_mov_b32 v28, 0
    v_mov_b32 v29, 0
    v_mov_b32 v30, 0
    v_mov_b32 v31, 0
    v_mov_b32 v32, 0
    v_mov_b32 v33, 0
    s_nop 1
L_nz:
    v_mov_b32_dpp v28, v10 wave_shr:1 row_mask:0xf bank_mask:0xf
    v_mov_b32_dpp v29, v11 wave_shr:1 row_mask:0xf bank_mask:0xf
    v_mov_b32_dpp v30, v12 wave_shr:1 row_mask:0xf bank_mask:0xf
    v_mov_b32_dpp v31, v13 wave_shr:1 row_mask:0xf bank_mask:0xf
    v_mov_b32_dpp v32, v14 wave_shr:1 row_mask:0xf bank_mask:0xf
    v_mov_b32_dpp v33, v15 wave_shr:1 row_mask:0xf bank_mask:0xf
    v_perm_b32 v44, v12, v14, s44
    v_perm_b32 v45, v8, v10, s44
    v_perm_b32 v46, v10, v12, s44
    v_perm_b32 v47, v32, v8, s44
    v_perm_b32 v48, v8, v10, s44
    v_perm_b32 v49, v30, v32, s44
    v_perm_b32 v50, v32, v8, s44
    v_perm_b32 v51, v28, v30, s44
    v_perm_b32 v52, v12, v14, s45
    v_perm_b32 v53, v8, v10, s45
    ds_write_b64 v93, v[44:45] offset:0
    v_perm_b32 v54, v10, v12, s45
    v_perm_b32 v55, v32, v8, s45
    ds_write_b64 v93, v[46:47] offset:4160
    v_perm_b32 v56, v8, v10, s45
    v_perm_b32 v57, v30, v32, s45
    ds_write_b64 v93, v[48:49] offset:8320
    v_perm_b32 v58, v32, v8, s45
    v_perm_b32 v59, v28, v30, s45
    ds_write_b64 v93, v[50:51] offset:12480
    v_perm_b32 v60, v13, v15, s44
    v_perm_b32 v61, v9, v11, s44
    ds_write_b64 v93, v[52:53] offset:16640
    v_perm_b32 v62, v11, v13, s44
    v_perm_b32 v63, v33, v9, s44
    ds_write_b64 v93, v[54:55] offset:20800
    v_perm_b32 v64, v9, v11, s44
    v_perm_b32 v65, v31, v33, s44
    ds_write_b64 v93, v[56:57] offset:24960
    v_perm_b32 v66, v33, v9, s44
    v_perm_b32 v67, v29, v31, s44
    ds_write_b64 v93, v[58:59] offset:29120
    v_perm_b32 v68, v13, v15, s45
    v_perm_b32 v69, v9, v11, s45
    ds_write_b64 v93, v[60:61] offset:33280
    v_perm_b32 v70, v11, v13, s45
    v_perm_b32 v71, v33, v9, s45
    ds_write_b64 v93, v[62:63] offset:37440
    v_perm_b32 v72, v9, v11, s45
    v_perm_b32 v73, v31, v33, s45
    ds_write_b64 v93, v[64:65] offset:41600
    v_perm_b32 v74, v33, v9, s45
    v_perm_b32 v75, v29, v31, s45
    ds_write_b64 v93, v[66:67] offset:45760
    ds_write_b64 v93, v[68:69] offset:49920
    ds_write_b64 v93, v[70:71] offset:54080
    ds_write_b64 v93, v[72:73] offset:58240
    ds_write_b64 v93, v[74:75] offset:62400
    s_cmp_lg_u32 s10, 0
    s_cbranch_scc1 L_nob1
    v_add_u32 v2, 0x100000, v2
    v_subrev_u32 v4, 3072, v2
    s_mov_b64 exec, 1
    global_load_dwordx2 v[36:37], v4, s[16:17] offset:0
    global_load_dwordx2 v[38:39], v4, s[16:17] offset:1024
    global_load_dwordx2 v[40:41], v4, s[16:17] offset:2048
    s_mov_b64 exec, -1
    global_load_dwordx2 v[18:19], v2, s[16:17] offset:0
    global_load_dwordx2 v[20:21], v2, s[16:17] offset:1024
    global_load_dwordx2 v[22:23], v2, s[16:17] offset:2048
    global_load_dwordx2 v[24:25], v2, s[16:17] offset:3072
L_nob1:
    s_waitcnt lgkmcnt(0)
    s_barrier
    s_setprio 3
    s_cmp_lg_u32 s10, 0
    s_cbranch_scc1 L_skipb1
    s_waitcnt vmcnt(0)
    v_mov_b32_dpp v36, v20 wave_shr:1 row_mask:0xf bank_mask:0xf
    v_mov_b32_dpp v37, v21 wave_shr:1 row_mask:0xf bank_mask:0xf
    v_mov_b32_dpp v38, v22 wave_shr:1 row_mask:0xf bank_mask:0xf
    v_mov_b32_dpp v39, v23 wave_shr:1 row_mask:0xf bank_mask:0xf
    v_mov_b32_dpp v40, v24 wave_shr:1 row_mask:0xf bank_mask:0xf
    v_mov_b32_dpp v41, v25 wave_shr:1 row_mask:0xf bank_mask:0xf
    v_subrev_u32 v93, 2048, v93
    v_perm_b32 v44, v22, v24, s44
    v_perm_b32 v45, v18, v20, s44
    v_perm_b32 v46, v20, v22, s44
    v_perm_b32 v47, v40, v18, s44
    v_perm_b32 v48, v18, v20, s44
    v_perm_b32 v49, v38, v40, s44
    v_perm_b32 v50, v40, v18, s44
    v_perm_b32 v51, v36, v38, s44
    v_perm_b32 v52, v22, v24, s45
    v_perm_b32 v53, v18, v20, s45
    ds_write_b64 v93, v[44:45] offset:0
    v_perm_b32 v54, v20, v22, s45
    v_perm_b32 v55, v40, v18, s45
    ds_write_b64 v93, v[46:47] offset:4160
    v_perm_b32 v56, v18, v20, s45
    v_perm_b32 v57, v38, v40, s45
    ds_write_b64 v93, v[48:49] offset:8320
    v_perm_b32 v58, v40, v18, s45
    v_perm_b32 v59, v36, v38, s45
    ds_write_b64 v93, v[50:51] offset:12480
    v_perm_b32 v60, v23, v25, s44
    v_perm_b32 v61, v19, v21, s44
    ds_write_b64 v93, v[52:53] offset:16640
    v_perm_b32 v62, v21, v23, s44
    v_perm_b32 v63, v41, v19, s44
    ds_write_b64 v93, v[54:55] offset:20800
    v_perm_b32 v64, v19, v21, s44
    v_perm_b32 v65, v39, v41, s44
    ds_write_b64 v93, v[56:57] offset:24960
    v_perm_b32 v66, v41, v19, s44
    v_perm_b32 v67, v37, v39, s44
    ds_write_b64 v93, v[58:59] offset:29120
    v_perm_b32 v68, v23, v25, s45
    v_perm_b32 v69, v19, v21, s45
    ds_write_b64 v93, v[60:61] offset:33280
    v_perm_b32 v70, v21, v23, s45
    v_perm_b32 v71, v41, v19, s45
    ds_write_b64 v93, v[62:63] offset:37440
    v_perm_b32 v72, v19, v21, s45
    v_perm_b32 v73, v39, v41, s45
    ds_write_b64 v93, v[64:65] offset:41600
    v_perm_b32 v74, v41, v19, s45
    v_perm_b32 v75, v37, v39, s45
    ds_write_b64 v93, v[66:67] offset:45760
    ds_write_b64 v93, v[68:69] offset:49920
    ds_write_b64 v93, v[70:71] offset:54080
    ds_write_b64 v93, v[72:73] offset:58240
    ds_write_b64 v93, v[74:75] offset:62400
L_skipb1:
    s_waitcnt lgkmcnt(0)
L_idle47:
    s_setprio 3
    s_sub_u32 s9, s4, 4
    s_lshl_b32 s11, s9, 6
    v_add_u32 v5, s11, v1
    v_lshlrev_b32 v7, 1, v5
    v_add_u32 v7, 121856, v7
    s_lshl_b32 s10, s7, 19
    s_lshl_b32 s11, s8, 1
    s_add_u32 s10, s10, s11
    v_lshlrev_b32 v8, 10, v5
    v_add_u32 v8, s10, v8
    s_lshl_b32 s12, s7, 20
    s_sub_u32 s12, 1572864, s12
    s_barrier
    ds_read_u16 v10, v7 offset:0
    ds_read_u16 v12, v7 offset:2048
    ds_read_u16 v11, v7 offset:4096
    ds_read_u16 v13, v7 offset:6144
    s_waitcnt lgkmcnt(2)
    v_lshl_or_b32 v10, v12, 16, v10
    s_waitcnt lgkmcnt(0)
    v_lshl_or_b32 v11, v13, 16, v11
    global_store_dwordx2 v8, v[10:11], s[34:35]
    v_add_u32 v8, s12, v8
    s_barrier
    ds_read_u16 v10, v7 offset:1024
    ds_read_u16 v12, v7 offset:3072
    ds_read_u16 v11, v7 offset:5120
    ds_read_u16 v13, v7 offset:7168
    s_waitcnt lgkmcnt(2)
    v_lshl_or_b32 v10, v12, 16, v10
    s_waitcnt lgkmcnt(0)
    v_lshl_or_b32 v11, v13, 16, v11
    global_store_dwordx2 v8, v[10:11], s[34:35]
L_fin:
L_end:
    s_endpgm
.section .rodata,"a"
.p2align 6
.amdhsa_kernel standalone__ssm_conv_s4__prompt_kernel
  .amdhsa_next_free_vgpr 168
  .amdhsa_next_free_sgpr 96
  .amdhsa_accum_offset 168
  .amdhsa_group_segment_fixed_size 0
  .amdhsa_kernarg_size 96
  .amdhsa_user_sgpr_count 2
  .amdhsa_user_sgpr_kernarg_segment_ptr 1
  .amdhsa_system_sgpr_workgroup_id_x 1
.end_amdhsa_kernel
```
